```python
import torch

def _softmax(x, axis=-1):
    return torch.softmax(x, dim=axis)
def _gelu(x):
    return torch.nn.functional.gelu(x, approximate="tanh")
def _silu(x):
    return torch.nn.functional.silu(x)
def _sigmoid(x):
    return torch.sigmoid(x)
def _layernorm(x, axis=-1, eps=1e-5):
    m = x.mean(dim=axis, keepdim=True)
    v = x.var(dim=axis, keepdim=True, unbiased=False)
    return (x - m) / torch.sqrt(v + eps)
def _scatter_add(tgt, idx, src, axis=0):
    return tgt.clone().index_add_(axis, idx, src)
def _segment_sum(src, seg, n):
    out = torch.zeros((n,) + src.shape[1:], dtype=src.dtype)
    return out.index_add_(0, seg, src)
def _pad(x, pw):
    flat = tuple(v for pair in reversed(pw) for v in pair)
    return torch.nn.functional.pad(x, flat)

kernel_name = 'parallel_sum__linear_attn_block__dense_activation_gelu__prompt'

def setup_inputs():

    _w = (lambda a: (lambda t: t.to(torch.bfloat16) if t.is_floating_point() else t)(torch.as_tensor(a)))
    def _A_setup():
        B, S, D = 1, 2048, 512
        return {
            "x": _w((lambda *s: torch.randn(*s, dtype=torch.bfloat16) * 0.05)(B, S, D)),
            "wqkv": _w((lambda *s: torch.randn(*s, dtype=torch.bfloat16) * 0.05)(D, 3 * D)),
            "wo": _w((lambda *s: torch.randn(*s, dtype=torch.bfloat16) * 0.05)(D, D)),
        }
    _A_in = _A_setup()

    def _B_setup():
        B, S, D, F = 1, 2048, 512, 1376
        return {
            "x": _w((lambda *s: torch.randn(*s, dtype=torch.bfloat16) * 0.05)(B, S, D)),
            "w1": _w((lambda *s: torch.randn(*s, dtype=torch.bfloat16) * 0.4)(D, F) * (D ** -0.5)),
            "b1": _w((lambda *s: torch.randn(*s, dtype=torch.bfloat16) * 12.8)(F) * 0.01),
            "w2": _w((lambda *s: torch.randn(*s, dtype=torch.bfloat16) * 0.1)(F, D) * (F ** -0.5)),
            "b2": _w((lambda *s: torch.randn(*s, dtype=torch.bfloat16) * 1.6)(D) * 0.01),
        }
    _B_in = _B_setup()

    return {
        "A_x": _A_in["x"],
        "A_wqkv": _A_in["wqkv"],
        "A_wo": _A_in["wo"],
        "B_x": _B_in["x"],
        "B_w1": _B_in["w1"],
        "B_b1": _B_in["b1"],
        "B_w2": _B_in["w2"],
        "B_b2": _B_in["b2"],
    }

def reference(A_x, A_wqkv, A_wo, B_x, B_w1, B_b1, B_w2, B_b2):
    def _A_ref(x, wqkv, wo):
        B, S, D = x.shape
        H = 32; Dh = D // H
        qkv = (lambda x, *d: x.permute(*d))((x @ wqkv).reshape(B, S, 3, H, Dh), 2, 0, 3, 1, 4)
        q, k, v = qkv[0], qkv[1], qkv[2]
        phi = lambda t: torch.where(t > 0, t + 1, torch.exp(t)) + 1e-6
        pq, pk = phi(q), phi(k)
        kv = torch.einsum("bhsd,bhse->bhde", pk, v)
        z = torch.einsum("bhsd->bhd", pk)
        num = torch.einsum("bhqd,bhde->bhqe", pq, kv)
        den = torch.einsum("bhqd,bhd->bhq", pq, z)[..., None] + 1e-6
        o = num / den
        return (lambda x, *d: x.permute(*d))(o, 0, 2, 1, 3).reshape(B, S, D) @ wo

    def _B_ref(x, w1, b1, w2, b2):
        h = torch.einsum("bsd,df->bsf", x, w1) + b1
        h = _gelu(h)
        return torch.einsum("bsf,fd->bsd", h, w2) + b2

    x = A_x
    xn = _layernorm(x, axis=-1)
    return x + _A_ref(xn, A_wqkv, A_wo) + _B_ref(xn, B_w1, B_b1, B_w2, B_b2)
```

```asm
; @launch grid=(256,1,1) block=(512,1,1) lds=163840
.amdgcn_target "amdgcn-amd-amdhsa--gfx950"
.text
.globl parallel_sum__linear_attn_block__dense_activation_gelu__prompt_kernel
.p2align 8
.type parallel_sum__linear_attn_block__dense_activation_gelu__prompt_kernel,@function
parallel_sum__linear_attn_block__dense_activation_gelu__prompt_kernel:
    s_cmp_ge_u32 s2, 256
    s_cbranch_scc1 L_END
    s_load_dwordx16 s[64:79], s[0:1], 0
    s_load_dwordx2 s[80:81], s[0:1], 64
    s_load_dwordx2 s[84:85], s[0:1], 80
    v_lshrrev_b32 v1, 6, v0
    v_and_b32 v0, 63, v0
    v_readfirstlane_b32 s3, v1
    s_and_b32 s44, s2, 7
    s_lshr_b32 s45, s2, 3
    s_lshr_b32 s46, s44, 2
    s_lshl_b32 s46, s46, 3
    s_and_b32 s47, s45, 7
    s_add_u32 s4, s46, s47
    s_lshr_b32 s46, s45, 3
    s_lshr_b32 s6, s46, 1
    s_and_b32 s47, s46, 1
    s_and_b32 s48, s44, 3
    s_lshl_b32 s48, s48, 1
    s_add_u32 s48, s48, s47
    s_lshl_b32 s47, s6, 3
    s_add_u32 s5, s48, s47
    s_lshl_b32 s40, s44, 2
    s_and_b32 s47, s45, 3
    s_add_u32 s40, s40, s47
    s_lshr_b32 s41, s45, 2
    s_lshl_b32 s7, s46, 1
    s_add_u32 s7, s7, s4
    s_and_b32 s47, s44, 1
    s_add_u32 s7, s7, s47
    s_and_b32 s7, s7, 7
    s_waitcnt lgkmcnt(0)
    s_load_dwordx2 s[42:43], s[84:85], 0
    s_mov_b32 s28, s84
    s_and_b32 s29, s85, 0xffff
    s_mov_b32 s30, 16777216
    s_mov_b32 s31, 0x20000
    s_cmp_ge_u32 s3, 4
    s_cbranch_scc1 L_HELPER
    s_lshr_b32 s50, s3, 1
    s_and_b32 s51, s3, 1
    s_cmp_lg_u32 s3, 0
    s_cbranch_scc1 L_C_NOINIT
    v_lshlrev_b32 v1, 2, v0
    v_add_u32 v1, 122880, v1
    v_cmp_eq_u32 vcc, 8, v0
    s_nop 1
    v_cndmask_b32 v2, 0, 2, vcc
    ds_write_b32 v1, v2
L_C_NOINIT:
    s_waitcnt lgkmcnt(0)
    s_mul_i32 s44, s42, 0x9E3779B1
    s_mul_i32 s43, s43, 0x85EBCA6B
    s_add_u32 s43, s43, s42
    s_add_u32 s43, s43, 0xC2B2AE35
    s_add_u32 s42, s44, 0x7F4A7C15
    s_barrier
    v_and_b32 v60, 31, v0
    v_lshrrev_b32 v61, 5, v0
    v_bfe_u32 v62, v0, 1, 3
    s_lshl_b32 s44, s50, 13
    v_lshlrev_b32 v63, 7, v60
    v_add_u32 v63, s44, v63
    v_add_u32 v64, 0, v61
    v_xor_b32 v64, v64, v62
    v_lshlrev_b32 v64, 4, v64
    v_add_u32 v2, v63, v64
    v_add_u32 v64, 2, v61
    v_xor_b32 v64, v64, v62
    v_lshlrev_b32 v64, 4, v64
    v_add_u32 v3, v63, v64
    v_add_u32 v64, 4, v61
    v_xor_b32 v64, v64, v62
    v_lshlrev_b32 v64, 4, v64
    v_add_u32 v4, v63, v64
    v_add_u32 v64, 6, v61
    v_xor_b32 v64, v64, v62
    v_lshlrev_b32 v64, 4, v64
    v_add_u32 v5, v63, v64
    v_bfe_u32 v64, v0, 2, 2
    v_lshl_add_u32 v65, v61, 3, v64
    v_lshlrev_b32 v65, 7, v65
    v_lshrrev_b32 v66, 1, v64
    v_xor_b32 v66, s51, v66
    v_lshl_add_u32 v65, v66, 6, v65
    v_bfe_u32 v66, v0, 4, 1
    v_lshl_add_u32 v65, v66, 5, v65
    v_and_b32 v66, 3, v0
    v_lshl_add_u32 v65, v66, 3, v65
    v_add_u32 v6, 16384, v65
    v_lshl_add_u32 v65, v61, 3, v64
    v_lshlrev_b32 v65, 8, v65
    v_xor_b32 v66, s51, v64
    v_lshl_add_u32 v65, v66, 6, v65
    v_bfe_u32 v66, v0, 4, 1
    v_lshl_add_u32 v65, v66, 5, v65
    v_and_b32 v66, 3, v0
    v_lshl_add_u32 v65, v66, 3, v65
    v_add_u32 v17, 24576, v65
    v_xor_b32 v18, 128, v17
    v_mov_b32 v8, 122880
    v_mov_b32 v9, 1
    s_mov_b32 s52, 0x3f803f80
    v_mov_b32 v160, 0
    v_mov_b32 v161, 0
    v_mov_b32 v162, 0
    v_mov_b32 v163, 0
    v_mov_b32 v164, 0
    v_mov_b32 v165, 0
    v_mov_b32 v166, 0
    v_mov_b32 v167, 0
    v_mov_b32 v168, 0
    v_mov_b32 v169, 0
    v_mov_b32 v170, 0
    v_mov_b32 v171, 0
    v_mov_b32 v172, 0
    v_mov_b32 v173, 0
    v_mov_b32 v174, 0
    v_mov_b32 v175, 0
    v_mov_b32 v176, 0
    v_mov_b32 v177, 0
    v_mov_b32 v178, 0
    v_mov_b32 v179, 0
    v_mov_b32 v180, 0
    v_mov_b32 v181, 0
    v_mov_b32 v182, 0
    v_mov_b32 v183, 0
    v_mov_b32 v184, 0
    v_mov_b32 v185, 0
    v_mov_b32 v186, 0
    v_mov_b32 v187, 0
    v_mov_b32 v188, 0
    v_mov_b32 v189, 0
    v_mov_b32 v190, 0
    v_mov_b32 v191, 0
    v_mov_b32 v192, 0
    v_mov_b32 v193, 0
    v_mov_b32 v194, 0
    v_mov_b32 v195, 0
    v_mov_b32 v196, 0
    v_mov_b32 v197, 0
    v_mov_b32 v198, 0
    v_mov_b32 v199, 0
    v_mov_b32 v200, 0
    v_mov_b32 v201, 0
    v_mov_b32 v202, 0
    v_mov_b32 v203, 0
    v_mov_b32 v204, 0
    v_mov_b32 v205, 0
    v_mov_b32 v206, 0
    v_mov_b32 v207, 0
    v_mov_b32 v208, 0
    v_mov_b32 v209, 0
    v_mov_b32 v210, 0
    v_mov_b32 v211, 0
    v_mov_b32 v212, 0
    v_mov_b32 v213, 0
    v_mov_b32 v214, 0
    v_mov_b32 v215, 0
    v_mov_b32 v216, 0
    v_mov_b32 v217, 0
    v_mov_b32 v218, 0
    v_mov_b32 v219, 0
    v_mov_b32 v220, 0
    v_mov_b32 v221, 0
    v_mov_b32 v222, 0
    v_mov_b32 v223, 0
    v_mov_b32 v224, 0
    v_mov_b32 v225, 0
    v_mov_b32 v226, 0
    v_mov_b32 v227, 0
    v_mov_b32 v228, 0
    v_mov_b32 v229, 0
    v_mov_b32 v230, 0
    v_mov_b32 v231, 0
    v_mov_b32 v232, 0
    v_mov_b32 v233, 0
    v_mov_b32 v234, 0
    v_mov_b32 v235, 0
    v_mov_b32 v236, 0
    v_mov_b32 v237, 0
    v_mov_b32 v238, 0
    v_mov_b32 v239, 0
    v_mov_b32 v240, 0
    v_mov_b32 v241, 0
    v_mov_b32 v242, 0
    v_mov_b32 v243, 0
    v_mov_b32 v244, 0
    v_mov_b32 v245, 0
    v_mov_b32 v246, 0
    v_mov_b32 v247, 0
    v_mov_b32 v248, 0
    v_mov_b32 v249, 0
    v_mov_b32 v250, 0
    v_mov_b32 v251, 0
    v_mov_b32 v252, 0
    v_mov_b32 v253, 0
    v_mov_b32 v254, 0
    v_mov_b32 v255, 0
    v_and_b32 v60, 31, v0
    v_lshlrev_b32 v60, 1, v60
    s_cmp_eq_u32 s6, 0
    s_cbranch_scc0 L_C_B1B
    s_lshl_b32 s53, s5, 1
    s_add_u32 s54, s53, s51
    s_mov_b32 s53, 64
    s_branch L_C_B1D
L_C_B1B:
    s_sub_u32 s53, s5, 8
    s_lshl_b32 s53, s53, 2
    s_add_u32 s53, s53, 16
    s_add_u32 s53, s53, s51
    s_add_u32 s54, s53, 2
L_C_B1D:
    s_cmp_eq_u32 s6, 0
    s_cbranch_scc0 L_TYPEB
    s_mov_b32 s45, 0
L_A_F0_sp:
    ds_read_b32 v1, v8 offset:0
    s_add_u32 s45, s45, 1
    s_waitcnt lgkmcnt(0)
    v_readfirstlane_b32 s44, v1
    s_cmp_ge_u32 s45, 262144
    s_cbranch_scc1 L_A_F0_ok
    s_cmp_ge_u32 s44, 2
    s_cbranch_scc0 L_A_F0_sp
L_A_F0_ok:
    s_waitcnt lgkmcnt(0)
    ds_read_b128 v[20:23], v2 offset:0
    ds_read_b64_tr_b16 v[36:37], v6 offset:0
    ds_read_b64_tr_b16 v[38:39], v6 offset:512
    ds_read_b128 v[24:27], v2 offset:4096
    ds_read_b64_tr_b16 v[40:41], v6 offset:8192
    ds_read_b64_tr_b16 v[42:43], v6 offset:8704
    ds_read_b64_tr_b16 v[44:45], v6 offset:16384
    ds_read_b64_tr_b16 v[46:47], v6 offset:16896
    s_mov_b32 s57, 0
    s_mov_b32 s58, 0
    s_mov_b32 s48, 4294885376
    s_mov_b32 s49, 40960
L_A_LOOP:
    s_waitcnt lgkmcnt(5)
    v_mfma_f32_32x32x16_bf16 v[160:175], v[20:23], v[36:39], v[160:175]
    ds_read_b128 v[28:31], v3 offset:0
    ds_read_b64_tr_b16 v[48:49], v6 offset:2048
    s_waitcnt lgkmcnt(6)
    v_mfma_f32_32x32x16_bf16 v[176:191], v[24:27], v[36:39], v[176:191]
    ds_read_b64_tr_b16 v[50:51], v6 offset:2560
    ds_read_b128 v[32:35], v3 offset:4096
    s_waitcnt lgkmcnt(6)
    v_mfma_f32_32x32x16_bf16 v[192:207], v[20:23], v[40:43], v[192:207]
    ds_read_b64_tr_b16 v[52:53], v6 offset:10240
    ds_read_b64_tr_b16 v[54:55], v6 offset:10752
    v_mfma_f32_32x32x16_bf16 v[208:223], v[24:27], v[40:43], v[208:223]
    ds_read_b64_tr_b16 v[56:57], v6 offset:18432
    ds_read_b64_tr_b16 v[58:59], v6 offset:18944
    s_waitcnt lgkmcnt(8)
    v_mfma_f32_32x32x16_bf16 v[224:239], v[44:47], v[20:23], v[224:239]
    v_mfma_f32_32x32x16_bf16 v[240:255], v[44:47], v[24:27], v[240:255]
    s_waitcnt lgkmcnt(5)
    v_mfma_f32_32x32x16_bf16 v[160:175], v[28:31], v[48:51], v[160:175]
    ds_read_b128 v[20:23], v4 offset:0
    ds_read_b64_tr_b16 v[36:37], v6 offset:4096
    s_waitcnt lgkmcnt(6)
    v_mfma_f32_32x32x16_bf16 v[176:191], v[32:35], v[48:51], v[176:191]
    ds_read_b64_tr_b16 v[38:39], v6 offset:4608
    ds_read_b128 v[24:27], v4 offset:4096
    s_waitcnt lgkmcnt(6)
    v_mfma_f32_32x32x16_bf16 v[192:207], v[28:31], v[52:55], v[192:207]
    ds_read_b64_tr_b16 v[40:41], v6 offset:12288
    ds_read_b64_tr_b16 v[42:43], v6 offset:12800
    v_mfma_f32_32x32x16_bf16 v[208:223], v[32:35], v[52:55], v[208:223]
    ds_read_b64_tr_b16 v[44:45], v6 offset:20480
    ds_read_b64_tr_b16 v[46:47], v6 offset:20992
    s_waitcnt lgkmcnt(8)
    v_mfma_f32_32x32x16_bf16 v[224:239], v[56:59], v[28:31], v[224:239]
    s_lshl_b32 s59, s57, 2
    v_add_u32 v63, s59, v8
    v_mfma_f32_32x32x16_bf16 v[240:255], v[56:59], v[32:35], v[240:255]
    s_waitcnt lgkmcnt(5)
    v_mfma_f32_32x32x16_bf16 v[160:175], v[20:23], v[36:39], v[160:175]
    ds_read_b128 v[28:31], v5 offset:0
    ds_read_b64_tr_b16 v[48:49], v6 offset:6144
    s_waitcnt lgkmcnt(6)
    v_mfma_f32_32x32x16_bf16 v[176:191], v[24:27], v[36:39], v[176:191]
    ds_read_b64_tr_b16 v[50:51], v6 offset:6656
    ds_read_b128 v[32:35], v5 offset:4096
    s_waitcnt lgkmcnt(6)
    v_mfma_f32_32x32x16_bf16 v[192:207], v[20:23], v[40:43], v[192:207]
    ds_read_b32 v7, v63 offset:4
    ds_read_b64_tr_b16 v[52:53], v6 offset:14336
    ds_read_b64_tr_b16 v[54:55], v6 offset:14848
    v_mfma_f32_32x32x16_bf16 v[208:223], v[24:27], v[40:43], v[208:223]
    ds_read_b64_tr_b16 v[56:57], v6 offset:22528
    ds_read_b64_tr_b16 v[58:59], v6 offset:23040
    s_waitcnt lgkmcnt(9)
    v_mfma_f32_32x32x16_bf16 v[224:239], v[44:47], v[20:23], v[224:239]
    s_cmp_eq_u32 s58, 2
    s_cselect_b32 s59, s48, s49
    v_mfma_f32_32x32x16_bf16 v[240:255], v[44:47], v[24:27], v[240:255]
    s_waitcnt lgkmcnt(4)
    v_readfirstlane_b32 s44, v7
    s_nop 1
    s_cmp_ge_u32 s44, 2
    s_cbranch_scc1 L_A_FOK
    v_add_u32 v1, 4, v63
    s_mov_b32 s45, 0
L_A_FS_sp:
    ds_read_b32 v7, v1 offset:0
    s_add_u32 s45, s45, 1
    s_waitcnt lgkmcnt(0)
    v_readfirstlane_b32 s44, v7
    s_cmp_ge_u32 s45, 262144
    s_cbranch_scc1 L_A_FS_ok
    s_cmp_ge_u32 s44, 2
    s_cbranch_scc0 L_A_FS_sp
L_A_FS_ok:
L_A_FOK:
    v_add_u32 v2, s59, v2
    v_add_u32 v6, s59, v6
    v_mfma_f32_32x32x16_bf16 v[160:175], v[28:31], v[48:51], v[160:175]
    ds_read_b128 v[20:23], v2 offset:0
    ds_read_b64_tr_b16 v[36:37], v6 offset:0
    s_waitcnt lgkmcnt(2)
    s_mov_b64 exec, 1
    ds_add_u32 v63, v9 offset:64
    s_mov_b64 exec, -1
    v_mfma_f32_32x32x16_bf16 v[176:191], v[32:35], v[48:51], v[176:191]
    ds_read_b64_tr_b16 v[38:39], v6 offset:512
    ds_read_b128 v[24:27], v2 offset:4096
    v_add_u32 v3, s59, v3
    v_mfma_f32_32x32x16_bf16 v[192:207], v[28:31], v[52:55], v[192:207]
    ds_read_b64_tr_b16 v[40:41], v6 offset:8192
    ds_read_b64_tr_b16 v[42:43], v6 offset:8704
    v_add_u32 v4, s59, v4
    v_mfma_f32_32x32x16_bf16 v[208:223], v[32:35], v[52:55], v[208:223]
    ds_read_b64_tr_b16 v[44:45], v6 offset:16384
    ds_read_b64_tr_b16 v[46:47], v6 offset:16896
    v_add_u32 v5, s59, v5
    v_mfma_f32_32x32x16_bf16 v[224:239], v[56:59], v[28:31], v[224:239]
    v_mfma_f32_32x32x16_bf16 v[240:255], v[56:59], v[32:35], v[240:255]
    s_add_u32 s58, s58, 1
    s_cmp_eq_u32 s58, 3
    s_cselect_b32 s58, 0, s58
    s_add_u32 s57, s57, 1
    s_cmp_lt_u32 s57, 8
    s_cbranch_scc1 L_A_LOOP
    s_waitcnt lgkmcnt(0)
    v_mov_b32 v72, 0
    v_mov_b32 v73, 0
    v_mov_b32 v74, 0
    v_mov_b32 v75, 0
    v_mov_b32 v76, 0
    v_mov_b32 v77, 0
    v_mov_b32 v78, 0
    v_mov_b32 v79, 0
    v_and_b32 v20, 31, v0
    s_lshl_b32 s44, s50, 10
    s_add_u32 s44, s44, 123136
    v_lshl_add_u32 v21, v20, 4, s44
    s_lshl_b32 s45, s51, 9
    s_add_u32 s45, s45, 126720
    v_lshl_add_u32 v22, v20, 4, s45
    s_lshl_b32 s46, s50, 9
    s_add_u32 s46, s46, 125184
    v_lshl_add_u32 v23, v20, 3, s46
    s_mov_b32 s45, 0
L_A_ST_sp:
    ds_read_b32 v1, v8 offset:132
    s_add_u32 s45, s45, 1
    s_waitcnt lgkmcnt(0)
    v_readfirstlane_b32 s44, v1
    s_cmp_ge_u32 s45, 262144
    s_cbranch_scc1 L_A_ST_ok
    s_cmp_ge_u32 s44, 1
    s_cbranch_scc0 L_A_ST_sp
L_A_ST_ok:
    ds_read_b128 v[80:83], v22
    ds_read_b128 v[84:87], v22 offset:1024
    ds_read_b128 v[88:91], v22 offset:2048
    ds_read_b64 v[24:25], v23
    ds_read_b64 v[26:27], v23 offset:256
    s_mov_b64 exec, 0xffffffff
    ds_read_b128 v[72:75], v21
    ds_read_b128 v[76:79], v21 offset:512
    s_mov_b64 exec, -1
    s_waitcnt lgkmcnt(0)
    v_mov_b32 v62, v24
    v_mov_b32 v66, v25
    v_mov_b32 v64, v26
    v_mov_b32 v68, v27
    v_mfma_f32_32x32x16_bf16 v[160:175], v[72:75], v[80:83], v[160:175]
    v_mfma_f32_32x32x16_bf16 v[176:191], v[76:79], v[80:83], v[176:191]
    v_mfma_f32_32x32x16_bf16 v[192:207], v[72:75], v[84:87], v[192:207]
    v_mfma_f32_32x32x16_bf16 v[208:223], v[76:79], v[84:87], v[208:223]
    v_mfma_f32_32x32x16_bf16 v[224:239], v[88:91], v[72:75], v[224:239]
    v_mfma_f32_32x32x16_bf16 v[240:255], v[88:91], v[76:79], v[240:255]
    s_mov_b32 s44, 0xc0135761
    s_mov_b32 s45, 0xbdd2d3e8
    s_mov_b32 s46, 0x3fb8aa3b
    v_mul_f32 v92, s44, v66
    v_mul_f32 v24, v66, v66
    v_mul_f32 v24, v24, v66
    v_mul_f32 v96, s45, v24
    v_mul_f32 v100, s46, v66
    v_mul_f32 v94, s44, v68
    v_mul_f32 v24, v68, v68
    v_mul_f32 v24, v24, v68
    v_mul_f32 v98, s45, v24
    v_mul_f32 v102, s46, v68
    v_mov_b32 v104, 0x358637bd
    v_lshlrev_b32 v105, 4, v0
    s_lshl_b32 s60, s4, 1
    s_add_u32 s60, s60, s50
    s_lshl_b32 s44, s50, 8
    s_add_u32 s44, s44, 126208
    v_lshrrev_b32 v22, 5, v0
    v_lshl_add_u32 v22, v22, 4, s44
    ds_read_b128 v[108:111], v22 offset:0
    ds_read_b128 v[112:115], v22 offset:32
    ds_read_b128 v[116:119], v22 offset:64
    ds_read_b128 v[120:123], v22 offset:96
    ds_read_b128 v[124:127], v22 offset:128
    ds_read_b128 v[128:131], v22 offset:160
    ds_read_b128 v[132:135], v22 offset:192
    ds_read_b128 v[136:139], v22 offset:224
    s_mov_b32 s44, 0x3fb8aa3b
    v_mov_b32 v106, s44
    s_waitcnt lgkmcnt(0)
    v_pk_mul_f32 v[140:141], v[160:161], v[108:109]
    v_pk_mul_f32 v[142:143], v[162:163], v[110:111]
    v_pk_mul_f32 v[144:145], v[164:165], v[112:113]
    v_pk_mul_f32 v[146:147], v[166:167], v[114:115]
    v_pk_mul_f32 v[148:149], v[140:141], v[106:107] op_sel_hi:[1,0]
    v_pk_mul_f32 v[150:151], v[142:143], v[106:107] op_sel_hi:[1,0]
    v_pk_mul_f32 v[152:153], v[144:145], v[106:107] op_sel_hi:[1,0]
    v_pk_mul_f32 v[154:155], v[146:147], v[106:107] op_sel_hi:[1,0]
    v_exp_f32_e64 v148, v148 clamp
    v_exp_f32_e64 v149, v149 clamp
    v_exp_f32_e64 v150, v150 clamp
    v_exp_f32_e64 v151, v151 clamp
    v_exp_f32_e64 v152, v152 clamp
    v_exp_f32_e64 v153, v153 clamp
    v_exp_f32_e64 v154, v154 clamp
    v_exp_f32_e64 v155, v155 clamp
    v_pk_add_f32 v[140:141], v[140:141], v[104:105] op_sel_hi:[1,0]
    v_pk_add_f32 v[142:143], v[142:143], v[104:105] op_sel_hi:[1,0]
    v_pk_add_f32 v[144:145], v[144:145], v[104:105] op_sel_hi:[1,0]
    v_pk_add_f32 v[146:147], v[146:147], v[104:105] op_sel_hi:[1,0]
    v_max_f32 v140, v140, v104
    v_max_f32 v141, v141, v104
    v_max_f32 v142, v142, v104
    v_max_f32 v143, v143, v104
    v_max_f32 v144, v144, v104
    v_max_f32 v145, v145, v104
    v_max_f32 v146, v146, v104
    v_max_f32 v147, v147, v104
    v_pk_add_f32 v[148:149], v[148:149], v[140:141]
    v_pk_add_f32 v[150:151], v[150:151], v[142:143]
    v_pk_add_f32 v[152:153], v[152:153], v[144:145]
    v_pk_add_f32 v[154:155], v[154:155], v[146:147]
    v_cvt_pk_bf16_f32 v20, v148, v149
    v_cvt_pk_bf16_f32 v21, v150, v151
    v_cvt_pk_bf16_f32 v22, v152, v153
    v_cvt_pk_bf16_f32 v23, v154, v155
    v_pk_mul_f32 v[140:141], v[168:169], v[116:117]
    v_pk_mul_f32 v[142:143], v[170:171], v[118:119]
    v_pk_mul_f32 v[144:145], v[172:173], v[120:121]
    v_pk_mul_f32 v[146:147], v[174:175], v[122:123]
    v_pk_mul_f32 v[148:149], v[140:141], v[106:107] op_sel_hi:[1,0]
    v_pk_mul_f32 v[150:151], v[142:143], v[106:107] op_sel_hi:[1,0]
    v_pk_mul_f32 v[152:153], v[144:145], v[106:107] op_sel_hi:[1,0]
    v_pk_mul_f32 v[154:155], v[146:147], v[106:107] op_sel_hi:[1,0]
    v_exp_f32_e64 v148, v148 clamp
    v_exp_f32_e64 v149, v149 clamp
    v_exp_f32_e64 v150, v150 clamp
    v_exp_f32_e64 v151, v151 clamp
    v_exp_f32_e64 v152, v152 clamp
    v_exp_f32_e64 v153, v153 clamp
    v_exp_f32_e64 v154, v154 clamp
    v_exp_f32_e64 v155, v155 clamp
    v_pk_add_f32 v[140:141], v[140:141], v[104:105] op_sel_hi:[1,0]
    v_pk_add_f32 v[142:143], v[142:143], v[104:105] op_sel_hi:[1,0]
    v_pk_add_f32 v[144:145], v[144:145], v[104:105] op_sel_hi:[1,0]
    v_pk_add_f32 v[146:147], v[146:147], v[104:105] op_sel_hi:[1,0]
    v_max_f32 v140, v140, v104
    v_max_f32 v141, v141, v104
    v_max_f32 v142, v142, v104
    v_max_f32 v143, v143, v104
    v_max_f32 v144, v144, v104
    v_max_f32 v145, v145, v104
    v_max_f32 v146, v146, v104
    v_max_f32 v147, v147, v104
    v_pk_add_f32 v[148:149], v[148:149], v[140:141]
    v_pk_add_f32 v[150:151], v[150:151], v[142:143]
    v_pk_add_f32 v[152:153], v[152:153], v[144:145]
    v_pk_add_f32 v[154:155], v[154:155], v[146:147]
    v_cvt_pk_bf16_f32 v24, v148, v149
    v_cvt_pk_bf16_f32 v25, v150, v151
    v_cvt_pk_bf16_f32 v26, v152, v153
    v_cvt_pk_bf16_f32 v27, v154, v155
    v_pk_mul_f32 v[140:141], v[192:193], v[108:109]
    v_cvt_pk_bf16_f32 v36, v140, v141
    v_pk_mul_f32 v[142:143], v[194:195], v[110:111]
    v_cvt_pk_bf16_f32 v37, v142, v143
    v_pk_mul_f32 v[144:145], v[196:197], v[112:113]
    v_cvt_pk_bf16_f32 v38, v144, v145
    v_pk_mul_f32 v[146:147], v[198:199], v[114:115]
    v_cvt_pk_bf16_f32 v39, v146, v147
    v_pk_mul_f32 v[140:141], v[200:201], v[116:117]
    v_cvt_pk_bf16_f32 v40, v140, v141
    v_pk_mul_f32 v[142:143], v[202:203], v[118:119]
    v_cvt_pk_bf16_f32 v41, v142, v143
    v_pk_mul_f32 v[144:145], v[204:205], v[120:121]
    v_cvt_pk_bf16_f32 v42, v144, v145
    v_pk_mul_f32 v[146:147], v[206:207], v[122:123]
    v_cvt_pk_bf16_f32 v43, v146, v147
    v_pk_mul_f32 v[140:141], v[176:177], v[124:125]
    v_pk_mul_f32 v[142:143], v[178:179], v[126:127]
    v_pk_mul_f32 v[144:145], v[180:181], v[128:129]
    v_pk_mul_f32 v[146:147], v[182:183], v[130:131]
    v_pk_mul_f32 v[148:149], v[140:141], v[106:107] op_sel_hi:[1,0]
    v_pk_mul_f32 v[150:151], v[142:143], v[106:107] op_sel_hi:[1,0]
    v_pk_mul_f32 v[152:153], v[144:145], v[106:107] op_sel_hi:[1,0]
    v_pk_mul_f32 v[154:155], v[146:147], v[106:107] op_sel_hi:[1,0]
    v_exp_f32_e64 v148, v148 clamp
    v_exp_f32_e64 v149, v149 clamp
    v_exp_f32_e64 v150, v150 clamp
    v_exp_f32_e64 v151, v151 clamp
    v_exp_f32_e64 v152, v152 clamp
    v_exp_f32_e64 v153, v153 clamp
    v_exp_f32_e64 v154, v154 clamp
    v_exp_f32_e64 v155, v155 clamp
    v_pk_add_f32 v[140:141], v[140:141], v[104:105] op_sel_hi:[1,0]
    v_pk_add_f32 v[142:143], v[142:143], v[104:105] op_sel_hi:[1,0]
    v_pk_add_f32 v[144:145], v[144:145], v[104:105] op_sel_hi:[1,0]
    v_pk_add_f32 v[146:147], v[146:147], v[104:105] op_sel_hi:[1,0]
    v_max_f32 v140, v140, v104
    v_max_f32 v141, v141, v104
    v_max_f32 v142, v142, v104
    v_max_f32 v143, v143, v104
    v_max_f32 v144, v144, v104
    v_max_f32 v145, v145, v104
    v_max_f32 v146, v146, v104
    v_max_f32 v147, v147, v104
    v_pk_add_f32 v[148:149], v[148:149], v[140:141]
    v_pk_add_f32 v[150:151], v[150:151], v[142:143]
    v_pk_add_f32 v[152:153], v[152:153], v[144:145]
    v_pk_add_f32 v[154:155], v[154:155], v[146:147]
    v_cvt_pk_bf16_f32 v28, v148, v149
    v_cvt_pk_bf16_f32 v29, v150, v151
    v_cvt_pk_bf16_f32 v30, v152, v153
    v_cvt_pk_bf16_f32 v31, v154, v155
    v_pk_mul_f32 v[140:141], v[184:185], v[132:133]
    v_pk_mul_f32 v[142:143], v[186:187], v[134:135]
    v_pk_mul_f32 v[144:145], v[188:189], v[136:137]
    v_pk_mul_f32 v[146:147], v[190:191], v[138:139]
    v_pk_mul_f32 v[148:149], v[140:141], v[106:107] op_sel_hi:[1,0]
    v_pk_mul_f32 v[150:151], v[142:143], v[106:107] op_sel_hi:[1,0]
    v_pk_mul_f32 v[152:153], v[144:145], v[106:107] op_sel_hi:[1,0]
    v_pk_mul_f32 v[154:155], v[146:147], v[106:107] op_sel_hi:[1,0]
    v_exp_f32_e64 v148, v148 clamp
    v_exp_f32_e64 v149, v149 clamp
    v_exp_f32_e64 v150, v150 clamp
    v_exp_f32_e64 v151, v151 clamp
    v_exp_f32_e64 v152, v152 clamp
    v_exp_f32_e64 v153, v153 clamp
    v_exp_f32_e64 v154, v154 clamp
    v_exp_f32_e64 v155, v155 clamp
    v_pk_add_f32 v[140:141], v[140:141], v[104:105] op_sel_hi:[1,0]
    v_pk_add_f32 v[142:143], v[142:143], v[104:105] op_sel_hi:[1,0]
    v_pk_add_f32 v[144:145], v[144:145], v[104:105] op_sel_hi:[1,0]
    v_pk_add_f32 v[146:147], v[146:147], v[104:105] op_sel_hi:[1,0]
    v_max_f32 v140, v140, v104
    v_max_f32 v141, v141, v104
    v_max_f32 v142, v142, v104
    v_max_f32 v143, v143, v104
    v_max_f32 v144, v144, v104
    v_max_f32 v145, v145, v104
    v_max_f32 v146, v146, v104
    v_max_f32 v147, v147, v104
    v_pk_add_f32 v[148:149], v[148:149], v[140:141]
    v_pk_add_f32 v[150:151], v[150:151], v[142:143]
    v_pk_add_f32 v[152:153], v[152:153], v[144:145]
    v_pk_add_f32 v[154:155], v[154:155], v[146:147]
    v_cvt_pk_bf16_f32 v32, v148, v149
    v_cvt_pk_bf16_f32 v33, v150, v151
    v_cvt_pk_bf16_f32 v34, v152, v153
    v_cvt_pk_bf16_f32 v35, v154, v155
    v_pk_mul_f32 v[140:141], v[208:209], v[124:125]
    v_cvt_pk_bf16_f32 v44, v140, v141
    v_pk_mul_f32 v[142:143], v[210:211], v[126:127]
    v_cvt_pk_bf16_f32 v45, v142, v143
    v_pk_mul_f32 v[144:145], v[212:213], v[128:129]
    v_cvt_pk_bf16_f32 v46, v144, v145
    v_pk_mul_f32 v[146:147], v[214:215], v[130:131]
    v_cvt_pk_bf16_f32 v47, v146, v147
    v_pk_mul_f32 v[140:141], v[216:217], v[132:133]
    v_cvt_pk_bf16_f32 v48, v140, v141
    v_pk_mul_f32 v[142:143], v[218:219], v[134:135]
    v_cvt_pk_bf16_f32 v49, v142, v143
    v_pk_mul_f32 v[144:145], v[220:221], v[136:137]
    v_cvt_pk_bf16_f32 v50, v144, v145
    v_pk_mul_f32 v[146:147], v[222:223], v[138:139]
    v_cvt_pk_bf16_f32 v51, v146, v147
    v_mov_b32 v52, s52
    v_mov_b32 v53, s52
    v_mov_b32 v54, s52
    v_mov_b32 v55, s52
    v_mfma_f32_32x32x16_bf16 v[160:175], v[20:23], v[36:39], 0
    s_nop 0
    v_mfma_f32_32x32x16_bf16 v[176:191], v[20:23], v[52:55], 0
    v_mfma_f32_32x32x16_bf16 v[160:175], v[24:27], v[40:43], v[160:175]
    v_mfma_f32_32x32x16_bf16 v[176:191], v[24:27], v[52:55], v[176:191]
    v_mfma_f32_32x32x16_bf16 v[160:175], v[28:31], v[44:47], v[160:175]
    v_mfma_f32_32x32x16_bf16 v[176:191], v[28:31], v[52:55], v[176:191]
    v_mfma_f32_32x32x16_bf16 v[160:175], v[32:35], v[48:51], v[160:175]
    v_mfma_f32_32x32x16_bf16 v[176:191], v[32:35], v[52:55], v[176:191]
    s_mul_i32 s61, s60, 176128
    s_lshl_b32 s44, s54, 12
    s_add_u32 s61, s61, s44
    s_add_u32 s61, s61, 4194304
    v_and_b32 v56, 16, v0
    v_cmp_ne_u32 vcc, 0, v56
    s_nop 4
    v_cndmask_b32 v124, v160, v168, vcc
    v_cndmask_b32 v140, v176, v184, vcc
    v_cndmask_b32 v125, v161, v169, vcc
    v_cndmask_b32 v141, v177, v185, vcc
    v_mov_b32 v126, s42
    v_mov_b32 v127, s43
    v_mov_b32 v142, s42
    v_mov_b32 v143, s43
    v_cndmask_b32 v128, v162, v170, vcc
    v_cndmask_b32 v144, v178, v186, vcc
    v_cndmask_b32 v129, v163, v171, vcc
    v_cndmask_b32 v145, v179, v187, vcc
    v_mov_b32 v130, s42
    v_mov_b32 v131, s43
    v_mov_b32 v146, s42
    v_mov_b32 v147, s43
    v_cndmask_b32 v132, v164, v172, vcc
    v_cndmask_b32 v148, v180, v188, vcc
    v_cndmask_b32 v133, v165, v173, vcc
    v_cndmask_b32 v149, v181, v189, vcc
    v_mov_b32 v134, s42
    v_mov_b32 v135, s43
    v_mov_b32 v150, s42
    v_mov_b32 v151, s43
    v_cndmask_b32 v136, v166, v174, vcc
    v_cndmask_b32 v152, v182, v190, vcc
    v_cndmask_b32 v137, v167, v175, vcc
    v_cndmask_b32 v153, v183, v191, vcc
    v_mov_b32 v138, s42
    v_mov_b32 v139, s43
    v_mov_b32 v154, s42
    v_mov_b32 v155, s43
    s_lshl_b32 s62, s5, 2
    s_lshl_b32 s44, s51, 1
    s_add_u32 s62, s62, s44
    s_lshl_b32 s44, s62, 16
    s_lshl_b32 s45, s60, 11
    s_add_u32 s44, s44, s45
    s_add_u32 s44, s44, 10485760
    v_bfe_u32 v56, v0, 4, 1
    v_lshlrev_b32 v57, 16, v56
    v_lshrrev_b32 v58, 5, v0
    v_lshl_add_u32 v57, v58, 9, v57
    v_and_b32 v59, 15, v0
    v_lshl_add_u32 v57, v59, 4, v57
    buffer_store_dwordx4 v[124:127], v57, s[28:31], s44 offen offset:0 sc1
    buffer_store_dwordx4 v[128:131], v57, s[28:31], s44 offen offset:256 sc1
    buffer_store_dwordx4 v[132:135], v57, s[28:31], s44 offen offset:1024 sc1
    buffer_store_dwordx4 v[136:139], v57, s[28:31], s44 offen offset:1280 sc1
    s_lshl_b32 s45, s62, 12
    s_lshl_b32 s46, s60, 4
    s_add_u32 s45, s45, s46
    s_add_u32 s45, s45, 131072
    v_lshlrev_b32 v57, 12, v56
    v_lshl_add_u32 v57, v58, 10, v57
    s_mov_b32 exec_lo, 0x00010001
    s_mov_b32 exec_hi, 0x00010001
    buffer_store_dwordx4 v[140:143], v57, s[28:31], s45 offen offset:0 sc1
    buffer_store_dwordx4 v[144:147], v57, s[28:31], s45 offen offset:512 sc1
    buffer_store_dwordx4 v[148:151], v57, s[28:31], s45 offen offset:2048 sc1
    buffer_store_dwordx4 v[152:155], v57, s[28:31], s45 offen offset:2560 sc1
    s_mov_b64 exec, -1
    v_pk_mul_f32 v[20:21], v[224:225], v[224:225]
    v_pk_mul_f32 v[22:23], v[226:227], v[226:227]
    v_pk_mul_f32 v[24:25], v[228:229], v[228:229]
    v_pk_mul_f32 v[26:27], v[230:231], v[230:231]
    v_pk_fma_f32 v[20:21], v[20:21], v[96:97], v[92:93] op_sel_hi:[1,0,0]
    v_pk_fma_f32 v[22:23], v[22:23], v[96:97], v[92:93] op_sel_hi:[1,0,0]
    v_pk_fma_f32 v[24:25], v[24:25], v[96:97], v[92:93] op_sel_hi:[1,0,0]
    v_pk_fma_f32 v[26:27], v[26:27], v[96:97], v[92:93] op_sel_hi:[1,0,0]
    v_pk_mul_f32 v[20:21], v[20:21], v[224:225]
    v_pk_mul_f32 v[22:23], v[22:23], v[226:227]
    v_pk_mul_f32 v[24:25], v[24:25], v[228:229]
    v_pk_mul_f32 v[26:27], v[26:27], v[230:231]
    v_exp_f32 v28, v20
    v_exp_f32 v29, v21
    v_exp_f32 v30, v22
    v_exp_f32 v31, v23
    v_exp_f32 v32, v24
    v_exp_f32 v33, v25
    v_exp_f32 v34, v26
    v_exp_f32 v35, v27
    v_pk_fma_f32 v[28:29], v[28:29], v[62:63], v[62:63] op_sel_hi:[1,0,0]
    v_pk_fma_f32 v[30:31], v[30:31], v[62:63], v[62:63] op_sel_hi:[1,0,0]
    v_pk_fma_f32 v[32:33], v[32:33], v[62:63], v[62:63] op_sel_hi:[1,0,0]
    v_pk_fma_f32 v[34:35], v[34:35], v[62:63], v[62:63] op_sel_hi:[1,0,0]
    v_rcp_f32 v28, v28
    v_rcp_f32 v29, v29
    v_rcp_f32 v30, v30
    v_rcp_f32 v31, v31
    v_rcp_f32 v32, v32
    v_rcp_f32 v33, v33
    v_rcp_f32 v34, v34
    v_rcp_f32 v35, v35
    v_pk_mul_f32 v[28:29], v[28:29], v[224:225]
    v_pk_mul_f32 v[30:31], v[30:31], v[226:227]
    v_pk_mul_f32 v[32:33], v[32:33], v[228:229]
    v_pk_mul_f32 v[34:35], v[34:35], v[230:231]
    v_cvt_pk_bf16_f32 v108, v28, v29
    v_cvt_pk_bf16_f32 v109, v30, v31
    v_cvt_pk_bf16_f32 v110, v32, v33
    v_cvt_pk_bf16_f32 v111, v34, v35
    v_pk_mul_f32 v[20:21], v[232:233], v[232:233]
    v_pk_mul_f32 v[22:23], v[234:235], v[234:235]
    v_pk_mul_f32 v[24:25], v[236:237], v[236:237]
    v_pk_mul_f32 v[26:27], v[238:239], v[238:239]
    v_pk_fma_f32 v[20:21], v[20:21], v[96:97], v[92:93] op_sel_hi:[1,0,0]
    v_pk_fma_f32 v[22:23], v[22:23], v[96:97], v[92:93] op_sel_hi:[1,0,0]
    v_pk_fma_f32 v[24:25], v[24:25], v[96:97], v[92:93] op_sel_hi:[1,0,0]
    v_pk_fma_f32 v[26:27], v[26:27], v[96:97], v[92:93] op_sel_hi:[1,0,0]
    v_pk_mul_f32 v[20:21], v[20:21], v[232:233]
    v_pk_mul_f32 v[22:23], v[22:23], v[234:235]
    v_pk_mul_f32 v[24:25], v[24:25], v[236:237]
    v_pk_mul_f32 v[26:27], v[26:27], v[238:239]
    v_exp_f32 v28, v20
    v_exp_f32 v29, v21
    v_exp_f32 v30, v22
    v_exp_f32 v31, v23
    v_exp_f32 v32, v24
    v_exp_f32 v33, v25
    v_exp_f32 v34, v26
    v_exp_f32 v35, v27
    v_pk_fma_f32 v[28:29], v[28:29], v[62:63], v[62:63] op_sel_hi:[1,0,0]
    v_pk_fma_f32 v[30:31], v[30:31], v[62:63], v[62:63] op_sel_hi:[1,0,0]
    v_pk_fma_f32 v[32:33], v[32:33], v[62:63], v[62:63] op_sel_hi:[1,0,0]
    v_pk_fma_f32 v[34:35], v[34:35], v[62:63], v[62:63] op_sel_hi:[1,0,0]
    v_rcp_f32 v28, v28
    v_rcp_f32 v29, v29
    v_rcp_f32 v30, v30
    v_rcp_f32 v31, v31
    v_rcp_f32 v32, v32
    v_rcp_f32 v33, v33
    v_rcp_f32 v34, v34
    v_rcp_f32 v35, v35
    v_pk_mul_f32 v[28:29], v[28:29], v[232:233]
    v_pk_mul_f32 v[30:31], v[30:31], v[234:235]
    v_pk_mul_f32 v[32:33], v[32:33], v[236:237]
    v_pk_mul_f32 v[34:35], v[34:35], v[238:239]
    v_cvt_pk_bf16_f32 v112, v28, v29
    v_cvt_pk_bf16_f32 v113, v30, v31
    v_cvt_pk_bf16_f32 v114, v32, v33
    v_cvt_pk_bf16_f32 v115, v34, v35
    buffer_store_dwordx4 v[108:111], v105, s[28:31], s61 offen offset:0 sc1
    buffer_store_dwordx4 v[112:115], v105, s[28:31], s61 offen offset:2048 sc1
    v_pk_mul_f32 v[20:21], v[240:241], v[240:241]
    v_pk_mul_f32 v[22:23], v[242:243], v[242:243]
    v_pk_mul_f32 v[24:25], v[244:245], v[244:245]
    v_pk_mul_f32 v[26:27], v[246:247], v[246:247]
    v_pk_fma_f32 v[20:21], v[20:21], v[98:99], v[94:95] op_sel_hi:[1,0,0]
    v_pk_fma_f32 v[22:23], v[22:23], v[98:99], v[94:95] op_sel_hi:[1,0,0]
    v_pk_fma_f32 v[24:25], v[24:25], v[98:99], v[94:95] op_sel_hi:[1,0,0]
    v_pk_fma_f32 v[26:27], v[26:27], v[98:99], v[94:95] op_sel_hi:[1,0,0]
    v_pk_mul_f32 v[20:21], v[20:21], v[240:241]
    v_pk_mul_f32 v[22:23], v[22:23], v[242:243]
    v_pk_mul_f32 v[24:25], v[24:25], v[244:245]
    v_pk_mul_f32 v[26:27], v[26:27], v[246:247]
    v_exp_f32 v28, v20
    v_exp_f32 v29, v21
    v_exp_f32 v30, v22
    v_exp_f32 v31, v23
    v_exp_f32 v32, v24
    v_exp_f32 v33, v25
    v_exp_f32 v34, v26
    v_exp_f32 v35, v27
    v_pk_fma_f32 v[28:29], v[28:29], v[64:65], v[64:65] op_sel_hi:[1,0,0]
    v_pk_fma_f32 v[30:31], v[30:31], v[64:65], v[64:65] op_sel_hi:[1,0,0]
    v_pk_fma_f32 v[32:33], v[32:33], v[64:65], v[64:65] op_sel_hi:[1,0,0]
    v_pk_fma_f32 v[34:35], v[34:35], v[64:65], v[64:65] op_sel_hi:[1,0,0]
    v_rcp_f32 v28, v28
    v_rcp_f32 v29, v29
    v_rcp_f32 v30, v30
    v_rcp_f32 v31, v31
    v_rcp_f32 v32, v32
    v_rcp_f32 v33, v33
    v_rcp_f32 v34, v34
    v_rcp_f32 v35, v35
    v_pk_mul_f32 v[28:29], v[28:29], v[240:241]
    v_pk_mul_f32 v[30:31], v[30:31], v[242:243]
    v_pk_mul_f32 v[32:33], v[32:33], v[244:245]
    v_pk_mul_f32 v[34:35], v[34:35], v[246:247]
    v_cvt_pk_bf16_f32 v116, v28, v29
    v_cvt_pk_bf16_f32 v117, v30, v31
    v_cvt_pk_bf16_f32 v118, v32, v33
    v_cvt_pk_bf16_f32 v119, v34, v35
    v_pk_mul_f32 v[20:21], v[248:249], v[248:249]
    v_pk_mul_f32 v[22:23], v[250:251], v[250:251]
    v_pk_mul_f32 v[24:25], v[252:253], v[252:253]
    v_pk_mul_f32 v[26:27], v[254:255], v[254:255]
    v_pk_fma_f32 v[20:21], v[20:21], v[98:99], v[94:95] op_sel_hi:[1,0,0]
    v_pk_fma_f32 v[22:23], v[22:23], v[98:99], v[94:95] op_sel_hi:[1,0,0]
    v_pk_fma_f32 v[24:25], v[24:25], v[98:99], v[94:95] op_sel_hi:[1,0,0]
    v_pk_fma_f32 v[26:27], v[26:27], v[98:99], v[94:95] op_sel_hi:[1,0,0]
    v_pk_mul_f32 v[20:21], v[20:21], v[248:249]
    v_pk_mul_f32 v[22:23], v[22:23], v[250:251]
    v_pk_mul_f32 v[24:25], v[24:25], v[252:253]
    v_pk_mul_f32 v[26:27], v[26:27], v[254:255]
    v_exp_f32 v28, v20
    v_exp_f32 v29, v21
    v_exp_f32 v30, v22
    v_exp_f32 v31, v23
    v_exp_f32 v32, v24
    v_exp_f32 v33, v25
    v_exp_f32 v34, v26
    v_exp_f32 v35, v27
    v_pk_fma_f32 v[28:29], v[28:29], v[64:65], v[64:65] op_sel_hi:[1,0,0]
    v_pk_fma_f32 v[30:31], v[30:31], v[64:65], v[64:65] op_sel_hi:[1,0,0]
    v_pk_fma_f32 v[32:33], v[32:33], v[64:65], v[64:65] op_sel_hi:[1,0,0]
    v_pk_fma_f32 v[34:35], v[34:35], v[64:65], v[64:65] op_sel_hi:[1,0,0]
    v_rcp_f32 v28, v28
    v_rcp_f32 v29, v29
    v_rcp_f32 v30, v30
    v_rcp_f32 v31, v31
    v_rcp_f32 v32, v32
    v_rcp_f32 v33, v33
    v_rcp_f32 v34, v34
    v_rcp_f32 v35, v35
    v_pk_mul_f32 v[28:29], v[28:29], v[248:249]
    v_pk_mul_f32 v[30:31], v[30:31], v[250:251]
    v_pk_mul_f32 v[32:33], v[32:33], v[252:253]
    v_pk_mul_f32 v[34:35], v[34:35], v[254:255]
    v_cvt_pk_bf16_f32 v120, v28, v29
    v_cvt_pk_bf16_f32 v121, v30, v31
    v_cvt_pk_bf16_f32 v122, v32, v33
    v_cvt_pk_bf16_f32 v123, v34, v35
    buffer_store_dwordx4 v[116:119], v105, s[28:31], s61 offen offset:1024 sc1
    buffer_store_dwordx4 v[120:123], v105, s[28:31], s61 offen offset:3072 sc1
    s_mov_b64 exec, 1
    ds_add_u32 v8, v9 offset:144
    s_mov_b64 exec, -1
    s_cmp_eq_u32 s3, 0
    s_cbranch_scc0 L_A_NORED
    s_and_b32 s61, s4, 3
    s_lshr_b32 s63, s4, 2
    s_lshl_b32 s62, s5, 2
    s_add_u32 s62, s62, s61
    v_lshrrev_b32 v20, 4, v0
    v_and_b32 v21, 15, v0
    v_lshlrev_b32 v22, 11, v20
    v_lshl_add_u32 v22, v21, 4, v22
    v_and_b32 v23, 31, v0
    v_lshlrev_b32 v23, 4, v23
    s_mov_b32 s48, 0
    s_lshl_b32 s47, s62, 12
    s_lshl_b32 s46, s63, 10
    s_add_u32 s47, s47, s46
    s_add_u32 s47, s47, 131072
L_RD_RETRY:
    s_lshl_b32 s44, s62, 16
    s_lshl_b32 s45, s63, 9
    s_add_u32 s44, s44, s45
    s_add_u32 s44, s44, 10485760
    buffer_load_dwordx4 v[24:27], v23, s[28:31], s47 offen sc1
    buffer_load_dwordx4 v[28:31], v23, s[28:31], s47 offen offset:512 sc1
    buffer_load_dwordx4 v[64:67], v22, s[28:31], s44 offen sc1
    buffer_load_dwordx4 v[68:71], v22, s[28:31], s44 offen offset:256 sc1
    s_add_u32 s44, s44, 8192
    buffer_load_dwordx4 v[72:75], v22, s[28:31], s44 offen sc1
    buffer_load_dwordx4 v[76:79], v22, s[28:31], s44 offen offset:256 sc1
    s_add_u32 s44, s44, 8192
    buffer_load_dwordx4 v[80:83], v22, s[28:31], s44 offen sc1
    buffer_load_dwordx4 v[84:87], v22, s[28:31], s44 offen offset:256 sc1
    s_add_u32 s44, s44, 8192
    buffer_load_dwordx4 v[88:91], v22, s[28:31], s44 offen sc1
    buffer_load_dwordx4 v[92:95], v22, s[28:31], s44 offen offset:256 sc1
    s_add_u32 s44, s44, 8192
    buffer_load_dwordx4 v[96:99], v22, s[28:31], s44 offen sc1
    buffer_load_dwordx4 v[100:103], v22, s[28:31], s44 offen offset:256 sc1
    s_add_u32 s44, s44, 8192
    buffer_load_dwordx4 v[104:107], v22, s[28:31], s44 offen sc1
    buffer_load_dwordx4 v[108:111], v22, s[28:31], s44 offen offset:256 sc1
    s_add_u32 s44, s44, 8192
    buffer_load_dwordx4 v[112:115], v22, s[28:31], s44 offen sc1
    buffer_load_dwordx4 v[116:119], v22, s[28:31], s44 offen offset:256 sc1
    s_add_u32 s44, s44, 8192
    buffer_load_dwordx4 v[120:123], v22, s[28:31], s44 offen sc1
    buffer_load_dwordx4 v[124:127], v22, s[28:31], s44 offen offset:256 sc1
    s_add_u32 s44, s44, 8192
    s_cmp_eq_u32 s48, 0
    s_cbranch_scc0 L_RD_NOFLAG
    s_waitcnt vmcnt(18)
    s_lshl_b32 s44, s60, 5
    s_lshl_b32 s45, s5, 1
    s_add_u32 s44, s44, s45
    s_add_u32 s44, s44, s51
    s_mul_i32 s44, s44, 32
    s_add_u32 s44, s44, 4096
    v_mov_b32 v60, s42
    v_mov_b32 v61, s43
    v_mov_b32 v62, 0
    s_mov_b64 exec, 1
    buffer_store_dwordx2 v[60:61], v62, s[28:31], s44 offen sc1
    s_mov_b64 exec, -1
    s_waitcnt vmcnt(1)
    s_branch L_RD_CHK
L_RD_NOFLAG:
    s_waitcnt vmcnt(0)
L_RD_CHK:
    v_xor_b32 v18, s42, v66
    v_xor_b32 v19, s43, v67
    v_or_b32 v18, v18, v19
    v_xor_b32 v19, s42, v70
    v_or_b32 v18, v18, v19
    v_xor_b32 v19, s43, v71
    v_or_b32 v18, v18, v19
    v_xor_b32 v19, s42, v74
    v_or_b32 v18, v18, v19
    v_xor_b32 v19, s43, v75
    v_or_b32 v18, v18, v19
    v_xor_b32 v19, s42, v78
    v_or_b32 v18, v18, v19
    v_xor_b32 v19, s43, v79
    v_or_b32 v18, v18, v19
    v_xor_b32 v19, s42, v82
    v_or_b32 v18, v18, v19
    v_xor_b32 v19, s43, v83
    v_or_b32 v18, v18, v19
    v_xor_b32 v19, s42, v86
    v_or_b32 v18, v18, v19
    v_xor_b32 v19, s43, v87
    v_or_b32 v18, v18, v19
    v_xor_b32 v19, s42, v90
    v_or_b32 v18, v18, v19
    v_xor_b32 v19, s43, v91
    v_or_b32 v18, v18, v19
    v_xor_b32 v19, s42, v94
    v_or_b32 v18, v18, v19
    v_xor_b32 v19, s43, v95
    v_or_b32 v18, v18, v19
    v_xor_b32 v19, s42, v98
    v_or_b32 v18, v18, v19
    v_xor_b32 v19, s43, v99
    v_or_b32 v18, v18, v19
    v_xor_b32 v19, s42, v102
    v_or_b32 v18, v18, v19
    v_xor_b32 v19, s43, v103
    v_or_b32 v18, v18, v19
    v_xor_b32 v19, s42, v106
    v_or_b32 v18, v18, v19
    v_xor_b32 v19, s43, v107
    v_or_b32 v18, v18, v19
    v_xor_b32 v19, s42, v110
    v_or_b32 v18, v18, v19
    v_xor_b32 v19, s43, v111
    v_or_b32 v18, v18, v19
    v_xor_b32 v19, s42, v114
    v_or_b32 v18, v18, v19
    v_xor_b32 v19, s43, v115
    v_or_b32 v18, v18, v19
    v_xor_b32 v19, s42, v118
    v_or_b32 v18, v18, v19
    v_xor_b32 v19, s43, v119
    v_or_b32 v18, v18, v19
    v_xor_b32 v19, s42, v122
    v_or_b32 v18, v18, v19
    v_xor_b32 v19, s43, v123
    v_or_b32 v18, v18, v19
    v_xor_b32 v19, s42, v126
    v_or_b32 v18, v18, v19
    v_xor_b32 v19, s43, v127
    v_or_b32 v18, v18, v19
    v_xor_b32 v19, s42, v26
    v_or_b32 v18, v18, v19
    v_xor_b32 v19, s43, v27
    v_or_b32 v18, v18, v19
    v_xor_b32 v19, s42, v30
    v_or_b32 v18, v18, v19
    v_xor_b32 v19, s43, v31
    v_or_b32 v18, v18, v19
    v_cmp_ne_u32 vcc, 0, v18
    s_add_u32 s48, s48, 1
    s_nop 0
    s_cmp_eq_u64 vcc, 0
    s_cbranch_scc1 L_RD_OK
    s_cmp_ge_u32 s48, 8192
    s_cbranch_scc1 L_RD_OK
    s_sleep 4
    s_branch L_RD_RETRY
L_RD_OK:
    v_add_f32 v64, v64, v72
    v_add_f32 v65, v65, v73
    v_add_f32 v68, v68, v76
    v_add_f32 v69, v69, v77
    v_add_f32 v64, v64, v80
    v_add_f32 v65, v65, v81
    v_add_f32 v68, v68, v84
    v_add_f32 v69, v69, v85
    v_add_f32 v64, v64, v88
    v_add_f32 v65, v65, v89
    v_add_f32 v68, v68, v92
    v_add_f32 v69, v69, v93
    v_add_f32 v64, v64, v96
    v_add_f32 v65, v65, v97
    v_add_f32 v68, v68, v100
    v_add_f32 v69, v69, v101
    v_add_f32 v64, v64, v104
    v_add_f32 v65, v65, v105
    v_add_f32 v68, v68, v108
    v_add_f32 v69, v69, v109
    v_add_f32 v64, v64, v112
    v_add_f32 v65, v65, v113
    v_add_f32 v68, v68, v116
    v_add_f32 v69, v69, v117
    v_add_f32 v64, v64, v120
    v_add_f32 v65, v65, v121
    v_add_f32 v68, v68, v124
    v_add_f32 v69, v69, v125
    v_mov_b32 v1, v64
    s_nop 1
    v_permlane32_swap_b32 v64, v1
    v_add_f32 v64, v64, v1
    v_mov_b32 v1, v64
    s_nop 1
    v_permlane16_swap_b32 v64, v1
    v_add_f32 v64, v64, v1
    v_mov_b32 v1, v65
    s_nop 1
    v_permlane32_swap_b32 v65, v1
    v_add_f32 v65, v65, v1
    v_mov_b32 v1, v65
    s_nop 1
    v_permlane16_swap_b32 v65, v1
    v_add_f32 v65, v65, v1
    v_mov_b32 v1, v68
    s_nop 1
    v_permlane32_swap_b32 v68, v1
    v_add_f32 v68, v68, v1
    v_mov_b32 v1, v68
    s_nop 1
    v_permlane16_swap_b32 v68, v1
    v_add_f32 v68, v68, v1
    v_mov_b32 v1, v69
    s_nop 1
    v_permlane32_swap_b32 v69, v1
    v_add_f32 v69, v69, v1
    v_mov_b32 v1, v69
    s_nop 1
    v_permlane16_swap_b32 v69, v1
    v_add_f32 v69, v69, v1
    v_add_f32_dpp v24, v24, v24 row_ror:8 row_mask:0xf bank_mask:0xf
    s_nop 1
    v_add_f32_dpp v24, v24, v24 row_ror:4 row_mask:0xf bank_mask:0xf
    s_nop 1
    v_add_f32_dpp v24, v24, v24 row_ror:2 row_mask:0xf bank_mask:0xf
    s_nop 1
    v_add_f32_dpp v24, v24, v24 row_ror:1 row_mask:0xf bank_mask:0xf
    v_mov_b32 v1, v24
    s_nop 1
    v_permlane16_swap_b32 v24, v1
    v_add_f32 v24, v24, v1
    v_add_f32_dpp v25, v25, v25 row_ror:8 row_mask:0xf bank_mask:0xf
    s_nop 1
    v_add_f32_dpp v25, v25, v25 row_ror:4 row_mask:0xf bank_mask:0xf
    s_nop 1
    v_add_f32_dpp v25, v25, v25 row_ror:2 row_mask:0xf bank_mask:0xf
    s_nop 1
    v_add_f32_dpp v25, v25, v25 row_ror:1 row_mask:0xf bank_mask:0xf
    v_mov_b32 v1, v25
    s_nop 1
    v_permlane16_swap_b32 v25, v1
    v_add_f32 v25, v25, v1
    v_add_f32_dpp v28, v28, v28 row_ror:8 row_mask:0xf bank_mask:0xf
    s_nop 1
    v_add_f32_dpp v28, v28, v28 row_ror:4 row_mask:0xf bank_mask:0xf
    s_nop 1
    v_add_f32_dpp v28, v28, v28 row_ror:2 row_mask:0xf bank_mask:0xf
    s_nop 1
    v_add_f32_dpp v28, v28, v28 row_ror:1 row_mask:0xf bank_mask:0xf
    v_mov_b32 v1, v28
    s_nop 1
    v_permlane16_swap_b32 v28, v1
    v_add_f32 v28, v28, v1
    v_add_f32_dpp v29, v29, v29 row_ror:8 row_mask:0xf bank_mask:0xf
    s_nop 1
    v_add_f32_dpp v29, v29, v29 row_ror:4 row_mask:0xf bank_mask:0xf
    s_nop 1
    v_add_f32_dpp v29, v29, v29 row_ror:2 row_mask:0xf bank_mask:0xf
    s_nop 1
    v_add_f32_dpp v29, v29, v29 row_ror:1 row_mask:0xf bank_mask:0xf
    v_mov_b32 v1, v29
    s_nop 1
    v_permlane16_swap_b32 v29, v1
    v_add_f32 v29, v29, v1
    v_cmp_gt_u32 vcc, 16, v0
    s_nop 1
    v_cndmask_b32 v24, v24, v64, vcc
    v_cndmask_b32 v25, v25, v65, vcc
    v_cndmask_b32 v28, v28, v68, vcc
    v_cndmask_b32 v29, v29, v69, vcc
    v_cvt_pk_bf16_f32 v16, v24, v25
    v_cvt_pk_bf16_f32 v17, v28, v29
    v_mov_b32 v18, s42
    v_mov_b32 v19, s43
    v_subrev_u32 v24, 16, v0
    v_lshlrev_b32 v24, 2, v24
    v_add_u32 v24, 16, v24
    v_cndmask_b32 v24, v24, v0, vcc
    v_lshlrev_b32 v24, 4, v24
    s_lshl_b32 s44, s62, 11
    s_lshl_b32 s45, s63, 9
    s_add_u32 s44, s44, s45
    s_add_u32 s44, s44, 65536
    s_mov_b64 exec, 0x3ffff
    buffer_store_dwordx4 v[16:19], v24, s[28:31], s44 offen sc1
    s_mov_b64 exec, -1
    s_branch L_A_DONE
L_A_NORED:
    s_waitcnt vmcnt(0)
    s_lshl_b32 s44, s60, 5
    s_lshl_b32 s45, s5, 1
    s_add_u32 s44, s44, s45
    s_add_u32 s44, s44, s51
    s_mul_i32 s44, s44, 32
    s_add_u32 s44, s44, 4096
    v_mov_b32 v60, s42
    v_mov_b32 v61, s43
    v_mov_b32 v62, 0
    s_mov_b64 exec, 1
    buffer_store_dwordx2 v[60:61], v62, s[28:31], s44 offen sc1
    s_mov_b64 exec, -1
    s_cmp_eq_u32 s3, 1
    s_cbranch_scc0 L_A_DONE
    s_cmp_eq_u32 s2, 0
    s_cbranch_scc0 L_A_DONE
    v_mul_u32_u24 v20, 32, v0
    s_mov_b32 s48, 0
L_EP_RETRY:
    s_mov_b32 s44, 4096
    buffer_load_dwordx2 v[64:65], v20, s[28:31], s44 offen sc1
    s_add_u32 s44, s44, 2048
    buffer_load_dwordx2 v[66:67], v20, s[28:31], s44 offen sc1
    s_add_u32 s44, s44, 2048
    buffer_load_dwordx2 v[68:69], v20, s[28:31], s44 offen sc1
    s_add_u32 s44, s44, 2048
    buffer_load_dwordx2 v[70:71], v20, s[28:31], s44 offen sc1
    s_add_u32 s44, s44, 2048
    buffer_load_dwordx2 v[72:73], v20, s[28:31], s44 offen sc1
    s_add_u32 s44, s44, 2048
    buffer_load_dwordx2 v[74:75], v20, s[28:31], s44 offen sc1
    s_add_u32 s44, s44, 2048
    buffer_load_dwordx2 v[76:77], v20, s[28:31], s44 offen sc1
    s_add_u32 s44, s44, 2048
    buffer_load_dwordx2 v[78:79], v20, s[28:31], s44 offen sc1
    s_add_u32 s44, s44, 2048
    buffer_load_dwordx2 v[80:81], v20, s[28:31], s44 offen sc1
    s_add_u32 s44, s44, 2048
    buffer_load_dwordx2 v[82:83], v20, s[28:31], s44 offen sc1
    s_add_u32 s44, s44, 2048
    buffer_load_dwordx2 v[84:85], v20, s[28:31], s44 offen sc1
    s_add_u32 s44, s44, 2048
    buffer_load_dwordx2 v[86:87], v20, s[28:31], s44 offen sc1
    s_add_u32 s44, s44, 2048
    buffer_load_dwordx2 v[88:89], v20, s[28:31], s44 offen sc1
    s_add_u32 s44, s44, 2048
    buffer_load_dwordx2 v[90:91], v20, s[28:31], s44 offen sc1
    s_add_u32 s44, s44, 2048
    buffer_load_dwordx2 v[92:93], v20, s[28:31], s44 offen sc1
    s_add_u32 s44, s44, 2048
    buffer_load_dwordx2 v[94:95], v20, s[28:31], s44 offen sc1
    s_add_u32 s44, s44, 2048
    s_waitcnt vmcnt(0)
    v_mov_b32 v22, 0
    v_xor_b32 v23, s42, v64
    v_or_b32 v22, v22, v23
    v_xor_b32 v23, s43, v65
    v_or_b32 v22, v22, v23
    v_xor_b32 v23, s42, v66
    v_or_b32 v22, v22, v23
    v_xor_b32 v23, s43, v67
    v_or_b32 v22, v22, v23
    v_xor_b32 v23, s42, v68
    v_or_b32 v22, v22, v23
    v_xor_b32 v23, s43, v69
    v_or_b32 v22, v22, v23
    v_xor_b32 v23, s42, v70
    v_or_b32 v22, v22, v23
    v_xor_b32 v23, s43, v71
    v_or_b32 v22, v22, v23
    v_xor_b32 v23, s42, v72
    v_or_b32 v22, v22, v23
    v_xor_b32 v23, s43, v73
    v_or_b32 v22, v22, v23
    v_xor_b32 v23, s42, v74
    v_or_b32 v22, v22, v23
    v_xor_b32 v23, s43, v75
    v_or_b32 v22, v22, v23
    v_xor_b32 v23, s42, v76
    v_or_b32 v22, v22, v23
    v_xor_b32 v23, s43, v77
    v_or_b32 v22, v22, v23
    v_xor_b32 v23, s42, v78
    v_or_b32 v22, v22, v23
    v_xor_b32 v23, s43, v79
    v_or_b32 v22, v22, v23
    v_xor_b32 v23, s42, v80
    v_or_b32 v22, v22, v23
    v_xor_b32 v23, s43, v81
    v_or_b32 v22, v22, v23
    v_xor_b32 v23, s42, v82
    v_or_b32 v22, v22, v23
    v_xor_b32 v23, s43, v83
    v_or_b32 v22, v22, v23
    v_xor_b32 v23, s42, v84
    v_or_b32 v22, v22, v23
    v_xor_b32 v23, s43, v85
    v_or_b32 v22, v22, v23
    v_xor_b32 v23, s42, v86
    v_or_b32 v22, v22, v23
    v_xor_b32 v23, s43, v87
    v_or_b32 v22, v22, v23
    v_xor_b32 v23, s42, v88
    v_or_b32 v22, v22, v23
    v_xor_b32 v23, s43, v89
    v_or_b32 v22, v22, v23
    v_xor_b32 v23, s42, v90
    v_or_b32 v22, v22, v23
    v_xor_b32 v23, s43, v91
    v_or_b32 v22, v22, v23
    v_xor_b32 v23, s42, v92
    v_or_b32 v22, v22, v23
    v_xor_b32 v23, s43, v93
    v_or_b32 v22, v22, v23
    v_xor_b32 v23, s42, v94
    v_or_b32 v22, v22, v23
    v_xor_b32 v23, s43, v95
    v_or_b32 v22, v22, v23
    v_cmp_ne_u32 vcc, 0, v22
    s_add_u32 s48, s48, 1
    s_nop 0
    s_cmp_eq_u64 vcc, 0
    s_cbranch_scc1 L_EP_OK
    s_cmp_ge_u32 s48, 8192
    s_cbranch_scc1 L_EP_OK
    s_sleep 8
    s_branch L_EP_RETRY
L_EP_OK:
    s_mov_b32 s44, 0
    v_mov_b32 v60, s42
    v_mov_b32 v61, s43
    v_mov_b32 v62, 0
    s_mov_b64 exec, 1
    buffer_store_dwordx2 v[60:61], v62, s[28:31], s44 offen sc1
    s_mov_b64 exec, -1
L_A_DONE:
    s_endpgm
L_TYPEB:
    s_mov_b32 s45, 0
L_B_F0_sp:
    ds_read_b32 v1, v8 offset:0
    s_add_u32 s45, s45, 1
    s_waitcnt lgkmcnt(0)
    v_readfirstlane_b32 s44, v1
    s_cmp_ge_u32 s45, 262144
    s_cbranch_scc1 L_B_F0_ok
    s_cmp_ge_u32 s44, 2
    s_cbranch_scc0 L_B_F0_sp
L_B_F0_ok:
    s_waitcnt lgkmcnt(0)
    ds_read_b128 v[20:23], v2 offset:0
    ds_read_b64_tr_b16 v[36:37], v6 offset:0
    ds_read_b64_tr_b16 v[38:39], v6 offset:512
    ds_read_b128 v[24:27], v2 offset:4096
    ds_read_b64_tr_b16 v[40:41], v17 offset:0
    ds_read_b64_tr_b16 v[42:43], v17 offset:1024
    ds_read_b64_tr_b16 v[44:45], v18 offset:0
    ds_read_b64_tr_b16 v[46:47], v18 offset:1024
    s_mov_b32 s57, 0
    s_mov_b32 s58, 0
    s_mov_b32 s48, 4294885376
    s_mov_b32 s49, 40960
L_B_LOOP:
    s_waitcnt lgkmcnt(5)
    v_mfma_f32_32x32x16_bf16 v[160:175], v[36:39], v[20:23], v[160:175]
    ds_read_b128 v[28:31], v3 offset:0
    ds_read_b64_tr_b16 v[48:49], v6 offset:2048
    s_waitcnt lgkmcnt(6)
    v_mfma_f32_32x32x16_bf16 v[176:191], v[36:39], v[24:27], v[176:191]
    ds_read_b64_tr_b16 v[50:51], v6 offset:2560
    ds_read_b128 v[32:35], v3 offset:4096
    s_waitcnt lgkmcnt(6)
    v_mfma_f32_32x32x16_bf16 v[192:207], v[40:43], v[20:23], v[192:207]
    ds_read_b64_tr_b16 v[52:53], v17 offset:4096
    ds_read_b64_tr_b16 v[54:55], v17 offset:5120
    v_mfma_f32_32x32x16_bf16 v[208:223], v[40:43], v[24:27], v[208:223]
    ds_read_b64_tr_b16 v[56:57], v18 offset:4096
    ds_read_b64_tr_b16 v[58:59], v18 offset:5120
    s_waitcnt lgkmcnt(8)
    v_mfma_f32_32x32x16_bf16 v[224:239], v[44:47], v[20:23], v[224:239]
    v_mfma_f32_32x32x16_bf16 v[240:255], v[44:47], v[24:27], v[240:255]
    s_waitcnt lgkmcnt(5)
    v_mfma_f32_32x32x16_bf16 v[160:175], v[48:51], v[28:31], v[160:175]
    ds_read_b128 v[20:23], v4 offset:0
    ds_read_b64_tr_b16 v[36:37], v6 offset:4096
    s_waitcnt lgkmcnt(6)
    v_mfma_f32_32x32x16_bf16 v[176:191], v[48:51], v[32:35], v[176:191]
    ds_read_b64_tr_b16 v[38:39], v6 offset:4608
    ds_read_b128 v[24:27], v4 offset:4096
    s_waitcnt lgkmcnt(6)
    v_mfma_f32_32x32x16_bf16 v[192:207], v[52:55], v[28:31], v[192:207]
    ds_read_b64_tr_b16 v[40:41], v17 offset:8192
    ds_read_b64_tr_b16 v[42:43], v17 offset:9216
    v_mfma_f32_32x32x16_bf16 v[208:223], v[52:55], v[32:35], v[208:223]
    ds_read_b64_tr_b16 v[44:45], v18 offset:8192
    ds_read_b64_tr_b16 v[46:47], v18 offset:9216
    s_waitcnt lgkmcnt(8)
    v_mfma_f32_32x32x16_bf16 v[224:239], v[56:59], v[28:31], v[224:239]
    s_lshl_b32 s59, s57, 2
    v_add_u32 v63, s59, v8
    v_mfma_f32_32x32x16_bf16 v[240:255], v[56:59], v[32:35], v[240:255]
    s_waitcnt lgkmcnt(5)
    v_mfma_f32_32x32x16_bf16 v[160:175], v[36:39], v[20:23], v[160:175]
    ds_read_b128 v[28:31], v5 offset:0
    ds_read_b64_tr_b16 v[48:49], v6 offset:6144
    s_waitcnt lgkmcnt(6)
    v_mfma_f32_32x32x16_bf16 v[176:191], v[36:39], v[24:27], v[176:191]
    ds_read_b64_tr_b16 v[50:51], v6 offset:6656
    ds_read_b128 v[32:35], v5 offset:4096
    s_waitcnt lgkmcnt(6)
    v_mfma_f32_32x32x16_bf16 v[192:207], v[40:43], v[20:23], v[192:207]
    ds_read_b32 v7, v63 offset:4
    ds_read_b64_tr_b16 v[52:53], v17 offset:12288
    ds_read_b64_tr_b16 v[54:55], v17 offset:13312
    v_mfma_f32_32x32x16_bf16 v[208:223], v[40:43], v[24:27], v[208:223]
    ds_read_b64_tr_b16 v[56:57], v18 offset:12288
    ds_read_b64_tr_b16 v[58:59], v18 offset:13312
    s_waitcnt lgkmcnt(9)
    v_mfma_f32_32x32x16_bf16 v[224:239], v[44:47], v[20:23], v[224:239]
    s_cmp_eq_u32 s58, 2
    s_cselect_b32 s59, s48, s49
    v_mfma_f32_32x32x16_bf16 v[240:255], v[44:47], v[24:27], v[240:255]
    s_waitcnt lgkmcnt(4)
    v_readfirstlane_b32 s44, v7
    s_nop 1
    s_cmp_ge_u32 s44, 2
    s_cbranch_scc1 L_B_FOK
    v_add_u32 v1, 4, v63
    s_mov_b32 s45, 0
L_B_FS_sp:
    ds_read_b32 v7, v1 offset:0
    s_add_u32 s45, s45, 1
    s_waitcnt lgkmcnt(0)
    v_readfirstlane_b32 s44, v7
    s_cmp_ge_u32 s45, 262144
    s_cbranch_scc1 L_B_FS_ok
    s_cmp_ge_u32 s44, 2
    s_cbranch_scc0 L_B_FS_sp
L_B_FS_ok:
L_B_FOK:
    v_add_u32 v2, s59, v2
    v_add_u32 v6, s59, v6
    v_add_u32 v17, s59, v17
    v_add_u32 v18, s59, v18
    v_mfma_f32_32x32x16_bf16 v[160:175], v[48:51], v[28:31], v[160:175]
    ds_read_b128 v[20:23], v2 offset:0
    ds_read_b64_tr_b16 v[36:37], v6 offset:0
    s_waitcnt lgkmcnt(2)
    s_mov_b64 exec, 1
    ds_add_u32 v63, v9 offset:64
    s_mov_b64 exec, -1
    v_mfma_f32_32x32x16_bf16 v[176:191], v[48:51], v[32:35], v[176:191]
    ds_read_b64_tr_b16 v[38:39], v6 offset:512
    ds_read_b128 v[24:27], v2 offset:4096
    v_add_u32 v3, s59, v3
    v_mfma_f32_32x32x16_bf16 v[192:207], v[52:55], v[28:31], v[192:207]
    ds_read_b64_tr_b16 v[40:41], v17 offset:0
    ds_read_b64_tr_b16 v[42:43], v17 offset:1024
    v_add_u32 v4, s59, v4
    v_mfma_f32_32x32x16_bf16 v[208:223], v[52:55], v[32:35], v[208:223]
    ds_read_b64_tr_b16 v[44:45], v18 offset:0
    ds_read_b64_tr_b16 v[46:47], v18 offset:1024
    v_add_u32 v5, s59, v5
    v_mfma_f32_32x32x16_bf16 v[224:239], v[56:59], v[28:31], v[224:239]
    v_mfma_f32_32x32x16_bf16 v[240:255], v[56:59], v[32:35], v[240:255]
    s_add_u32 s58, s58, 1
    s_cmp_eq_u32 s58, 3
    s_cselect_b32 s58, 0, s58
    s_add_u32 s57, s57, 1
    s_cmp_lt_u32 s57, 8
    s_cbranch_scc1 L_B_LOOP
    s_waitcnt lgkmcnt(0)
    v_mov_b32 v72, 0
    v_mov_b32 v73, 0
    v_mov_b32 v74, 0
    v_mov_b32 v75, 0
    v_mov_b32 v76, 0
    v_mov_b32 v77, 0
    v_mov_b32 v78, 0
    v_mov_b32 v79, 0
    v_and_b32 v20, 31, v0
    s_lshl_b32 s44, s50, 10
    s_add_u32 s44, s44, 123136
    v_lshl_add_u32 v21, v20, 4, s44
    s_lshl_b32 s45, s51, 9
    s_add_u32 s45, s45, 126720
    v_lshl_add_u32 v22, v20, 4, s45
    s_lshl_b32 s46, s50, 9
    s_add_u32 s46, s46, 125184
    v_lshl_add_u32 v23, v20, 3, s46
    s_mov_b32 s45, 0
L_B_ST_sp:
    ds_read_b32 v1, v8 offset:132
    s_add_u32 s45, s45, 1
    s_waitcnt lgkmcnt(0)
    v_readfirstlane_b32 s44, v1
    s_cmp_ge_u32 s45, 262144
    s_cbranch_scc1 L_B_ST_ok
    s_cmp_ge_u32 s44, 1
    s_cbranch_scc0 L_B_ST_sp
L_B_ST_ok:
    ds_read_b128 v[80:83], v22
    ds_read_b128 v[84:87], v22 offset:1024
    ds_read_b128 v[88:91], v22 offset:2048
    ds_read_b64 v[24:25], v23
    ds_read_b64 v[26:27], v23 offset:256
    s_mov_b64 exec, 0xffffffff
    ds_read_b128 v[72:75], v21
    ds_read_b128 v[76:79], v21 offset:512
    s_mov_b64 exec, -1
    s_waitcnt lgkmcnt(0)
    v_mov_b32 v62, v24
    v_mov_b32 v66, v25
    v_mov_b32 v64, v26
    v_mov_b32 v68, v27
    v_mfma_f32_32x32x16_bf16 v[160:175], v[80:83], v[72:75], v[160:175]
    v_mfma_f32_32x32x16_bf16 v[176:191], v[80:83], v[76:79], v[176:191]
    v_mfma_f32_32x32x16_bf16 v[192:207], v[84:87], v[72:75], v[192:207]
    v_mfma_f32_32x32x16_bf16 v[208:223], v[84:87], v[76:79], v[208:223]
    v_mfma_f32_32x32x16_bf16 v[224:239], v[88:91], v[72:75], v[224:239]
    v_mfma_f32_32x32x16_bf16 v[240:255], v[88:91], v[76:79], v[240:255]
    s_mov_b32 s44, 0xc0135761
    s_mov_b32 s45, 0xbdd2d3e8
    s_mov_b32 s46, 0x3fb8aa3b
    v_mul_f32 v92, s44, v66
    v_mul_f32 v24, v66, v66
    v_mul_f32 v24, v24, v66
    v_mul_f32 v96, s45, v24
    v_mul_f32 v100, s46, v66
    v_mul_f32 v94, s44, v68
    v_mul_f32 v24, v68, v68
    v_mul_f32 v24, v24, v68
    v_mul_f32 v98, s45, v24
    v_mul_f32 v102, s46, v68
    v_mov_b32 v104, 0x358637bd
    v_lshlrev_b32 v105, 4, v0
    s_lshl_b32 s60, s4, 1
    s_add_u32 s60, s60, s50
    s_cmp_lt_u32 s53, 43
    s_cbranch_scc0 L_B_SKIP1
    s_mul_i32 s61, s60, 176128
    s_lshl_b32 s44, s53, 12
    s_add_u32 s61, s61, s44
    s_add_u32 s61, s61, 4194304
    v_pk_mul_f32 v[140:141], v[192:193], v[192:193]
    v_pk_mul_f32 v[142:143], v[194:195], v[194:195]
    v_pk_mul_f32 v[144:145], v[196:197], v[196:197]
    v_pk_mul_f32 v[146:147], v[198:199], v[198:199]
    v_pk_fma_f32 v[140:141], v[140:141], v[96:97], v[92:93] op_sel_hi:[1,0,0]
    v_pk_fma_f32 v[142:143], v[142:143], v[96:97], v[92:93] op_sel_hi:[1,0,0]
    v_pk_fma_f32 v[144:145], v[144:145], v[96:97], v[92:93] op_sel_hi:[1,0,0]
    v_pk_fma_f32 v[146:147], v[146:147], v[96:97], v[92:93] op_sel_hi:[1,0,0]
    v_pk_mul_f32 v[140:141], v[140:141], v[192:193]
    v_pk_mul_f32 v[142:143], v[142:143], v[194:195]
    v_pk_mul_f32 v[144:145], v[144:145], v[196:197]
    v_pk_mul_f32 v[146:147], v[146:147], v[198:199]
    v_exp_f32 v148, v140
    v_exp_f32 v149, v141
    v_exp_f32 v150, v142
    v_exp_f32 v151, v143
    v_exp_f32 v152, v144
    v_exp_f32 v153, v145
    v_exp_f32 v154, v146
    v_exp_f32 v155, v147
    v_pk_fma_f32 v[148:149], v[148:149], v[62:63], v[62:63] op_sel_hi:[1,0,0]
    v_pk_fma_f32 v[150:151], v[150:151], v[62:63], v[62:63] op_sel_hi:[1,0,0]
    v_pk_fma_f32 v[152:153], v[152:153], v[62:63], v[62:63] op_sel_hi:[1,0,0]
    v_pk_fma_f32 v[154:155], v[154:155], v[62:63], v[62:63] op_sel_hi:[1,0,0]
    v_rcp_f32 v148, v148
    v_rcp_f32 v149, v149
    v_rcp_f32 v150, v150
    v_rcp_f32 v151, v151
    v_rcp_f32 v152, v152
    v_rcp_f32 v153, v153
    v_rcp_f32 v154, v154
    v_rcp_f32 v155, v155
    v_pk_mul_f32 v[148:149], v[148:149], v[192:193]
    v_pk_mul_f32 v[150:151], v[150:151], v[194:195]
    v_pk_mul_f32 v[152:153], v[152:153], v[196:197]
    v_pk_mul_f32 v[154:155], v[154:155], v[198:199]
    v_cvt_pk_bf16_f32 v124, v148, v149
    v_cvt_pk_bf16_f32 v125, v150, v151
    v_cvt_pk_bf16_f32 v126, v152, v153
    v_cvt_pk_bf16_f32 v127, v154, v155
    v_pk_mul_f32 v[140:141], v[200:201], v[200:201]
    v_pk_mul_f32 v[142:143], v[202:203], v[202:203]
    v_pk_mul_f32 v[144:145], v[204:205], v[204:205]
    v_pk_mul_f32 v[146:147], v[206:207], v[206:207]
    v_pk_fma_f32 v[140:141], v[140:141], v[96:97], v[92:93] op_sel_hi:[1,0,0]
    v_pk_fma_f32 v[142:143], v[142:143], v[96:97], v[92:93] op_sel_hi:[1,0,0]
    v_pk_fma_f32 v[144:145], v[144:145], v[96:97], v[92:93] op_sel_hi:[1,0,0]
    v_pk_fma_f32 v[146:147], v[146:147], v[96:97], v[92:93] op_sel_hi:[1,0,0]
    v_pk_mul_f32 v[140:141], v[140:141], v[200:201]
    v_pk_mul_f32 v[142:143], v[142:143], v[202:203]
    v_pk_mul_f32 v[144:145], v[144:145], v[204:205]
    v_pk_mul_f32 v[146:147], v[146:147], v[206:207]
    v_exp_f32 v148, v140
    v_exp_f32 v149, v141
    v_exp_f32 v150, v142
    v_exp_f32 v151, v143
    v_exp_f32 v152, v144
    v_exp_f32 v153, v145
    v_exp_f32 v154, v146
    v_exp_f32 v155, v147
    v_pk_fma_f32 v[148:149], v[148:149], v[62:63], v[62:63] op_sel_hi:[1,0,0]
    v_pk_fma_f32 v[150:151], v[150:151], v[62:63], v[62:63] op_sel_hi:[1,0,0]
    v_pk_fma_f32 v[152:153], v[152:153], v[62:63], v[62:63] op_sel_hi:[1,0,0]
    v_pk_fma_f32 v[154:155], v[154:155], v[62:63], v[62:63] op_sel_hi:[1,0,0]
    v_rcp_f32 v148, v148
    v_rcp_f32 v149, v149
    v_rcp_f32 v150, v150
    v_rcp_f32 v151, v151
    v_rcp_f32 v152, v152
    v_rcp_f32 v153, v153
    v_rcp_f32 v154, v154
    v_rcp_f32 v155, v155
    v_pk_mul_f32 v[148:149], v[148:149], v[200:201]
    v_pk_mul_f32 v[150:151], v[150:151], v[202:203]
    v_pk_mul_f32 v[152:153], v[152:153], v[204:205]
    v_pk_mul_f32 v[154:155], v[154:155], v[206:207]
    v_cvt_pk_bf16_f32 v128, v148, v149
    v_cvt_pk_bf16_f32 v129, v150, v151
    v_cvt_pk_bf16_f32 v130, v152, v153
    v_cvt_pk_bf16_f32 v131, v154, v155
    buffer_store_dwordx4 v[124:127], v105, s[28:31], s61 offen offset:0 sc1
    buffer_store_dwordx4 v[128:131], v105, s[28:31], s61 offen offset:2048 sc1
    v_pk_mul_f32 v[140:141], v[208:209], v[208:209]
    v_pk_mul_f32 v[142:143], v[210:211], v[210:211]
    v_pk_mul_f32 v[144:145], v[212:213], v[212:213]
    v_pk_mul_f32 v[146:147], v[214:215], v[214:215]
    v_pk_fma_f32 v[140:141], v[140:141], v[98:99], v[94:95] op_sel_hi:[1,0,0]
    v_pk_fma_f32 v[142:143], v[142:143], v[98:99], v[94:95] op_sel_hi:[1,0,0]
    v_pk_fma_f32 v[144:145], v[144:145], v[98:99], v[94:95] op_sel_hi:[1,0,0]
    v_pk_fma_f32 v[146:147], v[146:147], v[98:99], v[94:95] op_sel_hi:[1,0,0]
    v_pk_mul_f32 v[140:141], v[140:141], v[208:209]
    v_pk_mul_f32 v[142:143], v[142:143], v[210:211]
    v_pk_mul_f32 v[144:145], v[144:145], v[212:213]
    v_pk_mul_f32 v[146:147], v[146:147], v[214:215]
    v_exp_f32 v148, v140
    v_exp_f32 v149, v141
    v_exp_f32 v150, v142
    v_exp_f32 v151, v143
    v_exp_f32 v152, v144
    v_exp_f32 v153, v145
    v_exp_f32 v154, v146
    v_exp_f32 v155, v147
    v_pk_fma_f32 v[148:149], v[148:149], v[64:65], v[64:65] op_sel_hi:[1,0,0]
    v_pk_fma_f32 v[150:151], v[150:151], v[64:65], v[64:65] op_sel_hi:[1,0,0]
    v_pk_fma_f32 v[152:153], v[152:153], v[64:65], v[64:65] op_sel_hi:[1,0,0]
    v_pk_fma_f32 v[154:155], v[154:155], v[64:65], v[64:65] op_sel_hi:[1,0,0]
    v_rcp_f32 v148, v148
    v_rcp_f32 v149, v149
    v_rcp_f32 v150, v150
    v_rcp_f32 v151, v151
    v_rcp_f32 v152, v152
    v_rcp_f32 v153, v153
    v_rcp_f32 v154, v154
    v_rcp_f32 v155, v155
    v_pk_mul_f32 v[148:149], v[148:149], v[208:209]
    v_pk_mul_f32 v[150:151], v[150:151], v[210:211]
    v_pk_mul_f32 v[152:153], v[152:153], v[212:213]
    v_pk_mul_f32 v[154:155], v[154:155], v[214:215]
    v_cvt_pk_bf16_f32 v132, v148, v149
    v_cvt_pk_bf16_f32 v133, v150, v151
    v_cvt_pk_bf16_f32 v134, v152, v153
    v_cvt_pk_bf16_f32 v135, v154, v155
    v_pk_mul_f32 v[140:141], v[216:217], v[216:217]
    v_pk_mul_f32 v[142:143], v[218:219], v[218:219]
    v_pk_mul_f32 v[144:145], v[220:221], v[220:221]
    v_pk_mul_f32 v[146:147], v[222:223], v[222:223]
    v_pk_fma_f32 v[140:141], v[140:141], v[98:99], v[94:95] op_sel_hi:[1,0,0]
    v_pk_fma_f32 v[142:143], v[142:143], v[98:99], v[94:95] op_sel_hi:[1,0,0]
    v_pk_fma_f32 v[144:145], v[144:145], v[98:99], v[94:95] op_sel_hi:[1,0,0]
    v_pk_fma_f32 v[146:147], v[146:147], v[98:99], v[94:95] op_sel_hi:[1,0,0]
    v_pk_mul_f32 v[140:141], v[140:141], v[216:217]
    v_pk_mul_f32 v[142:143], v[142:143], v[218:219]
    v_pk_mul_f32 v[144:145], v[144:145], v[220:221]
    v_pk_mul_f32 v[146:147], v[146:147], v[222:223]
    v_exp_f32 v148, v140
    v_exp_f32 v149, v141
    v_exp_f32 v150, v142
    v_exp_f32 v151, v143
    v_exp_f32 v152, v144
    v_exp_f32 v153, v145
    v_exp_f32 v154, v146
    v_exp_f32 v155, v147
    v_pk_fma_f32 v[148:149], v[148:149], v[64:65], v[64:65] op_sel_hi:[1,0,0]
    v_pk_fma_f32 v[150:151], v[150:151], v[64:65], v[64:65] op_sel_hi:[1,0,0]
    v_pk_fma_f32 v[152:153], v[152:153], v[64:65], v[64:65] op_sel_hi:[1,0,0]
    v_pk_fma_f32 v[154:155], v[154:155], v[64:65], v[64:65] op_sel_hi:[1,0,0]
    v_rcp_f32 v148, v148
    v_rcp_f32 v149, v149
    v_rcp_f32 v150, v150
    v_rcp_f32 v151, v151
    v_rcp_f32 v152, v152
    v_rcp_f32 v153, v153
    v_rcp_f32 v154, v154
    v_rcp_f32 v155, v155
    v_pk_mul_f32 v[148:149], v[148:149], v[216:217]
    v_pk_mul_f32 v[150:151], v[150:151], v[218:219]
    v_pk_mul_f32 v[152:153], v[152:153], v[220:221]
    v_pk_mul_f32 v[154:155], v[154:155], v[222:223]
    v_cvt_pk_bf16_f32 v136, v148, v149
    v_cvt_pk_bf16_f32 v137, v150, v151
    v_cvt_pk_bf16_f32 v138, v152, v153
    v_cvt_pk_bf16_f32 v139, v154, v155
    buffer_store_dwordx4 v[132:135], v105, s[28:31], s61 offen offset:1024 sc1
    buffer_store_dwordx4 v[136:139], v105, s[28:31], s61 offen offset:3072 sc1
L_B_SKIP1:
    s_cmp_lt_u32 s54, 43
    s_cbranch_scc0 L_B_SKIP2
    s_mul_i32 s61, s60, 176128
    s_lshl_b32 s44, s54, 12
    s_add_u32 s61, s61, s44
    s_add_u32 s61, s61, 4194304
    v_pk_mul_f32 v[140:141], v[224:225], v[224:225]
    v_pk_mul_f32 v[142:143], v[226:227], v[226:227]
    v_pk_mul_f32 v[144:145], v[228:229], v[228:229]
    v_pk_mul_f32 v[146:147], v[230:231], v[230:231]
    v_pk_fma_f32 v[140:141], v[140:141], v[96:97], v[92:93] op_sel_hi:[1,0,0]
    v_pk_fma_f32 v[142:143], v[142:143], v[96:97], v[92:93] op_sel_hi:[1,0,0]
    v_pk_fma_f32 v[144:145], v[144:145], v[96:97], v[92:93] op_sel_hi:[1,0,0]
    v_pk_fma_f32 v[146:147], v[146:147], v[96:97], v[92:93] op_sel_hi:[1,0,0]
    v_pk_mul_f32 v[140:141], v[140:141], v[224:225]
    v_pk_mul_f32 v[142:143], v[142:143], v[226:227]
    v_pk_mul_f32 v[144:145], v[144:145], v[228:229]
    v_pk_mul_f32 v[146:147], v[146:147], v[230:231]
    v_exp_f32 v148, v140
    v_exp_f32 v149, v141
    v_exp_f32 v150, v142
    v_exp_f32 v151, v143
    v_exp_f32 v152, v144
    v_exp_f32 v153, v145
    v_exp_f32 v154, v146
    v_exp_f32 v155, v147
    v_pk_fma_f32 v[148:149], v[148:149], v[62:63], v[62:63] op_sel_hi:[1,0,0]
    v_pk_fma_f32 v[150:151], v[150:151], v[62:63], v[62:63] op_sel_hi:[1,0,0]
    v_pk_fma_f32 v[152:153], v[152:153], v[62:63], v[62:63] op_sel_hi:[1,0,0]
    v_pk_fma_f32 v[154:155], v[154:155], v[62:63], v[62:63] op_sel_hi:[1,0,0]
    v_rcp_f32 v148, v148
    v_rcp_f32 v149, v149
    v_rcp_f32 v150, v150
    v_rcp_f32 v151, v151
    v_rcp_f32 v152, v152
    v_rcp_f32 v153, v153
    v_rcp_f32 v154, v154
    v_rcp_f32 v155, v155
    v_pk_mul_f32 v[148:149], v[148:149], v[224:225]
    v_pk_mul_f32 v[150:151], v[150:151], v[226:227]
    v_pk_mul_f32 v[152:153], v[152:153], v[228:229]
    v_pk_mul_f32 v[154:155], v[154:155], v[230:231]
    v_cvt_pk_bf16_f32 v108, v148, v149
    v_cvt_pk_bf16_f32 v109, v150, v151
    v_cvt_pk_bf16_f32 v110, v152, v153
    v_cvt_pk_bf16_f32 v111, v154, v155
    v_pk_mul_f32 v[140:141], v[232:233], v[232:233]
    v_pk_mul_f32 v[142:143], v[234:235], v[234:235]
    v_pk_mul_f32 v[144:145], v[236:237], v[236:237]
    v_pk_mul_f32 v[146:147], v[238:239], v[238:239]
    v_pk_fma_f32 v[140:141], v[140:141], v[96:97], v[92:93] op_sel_hi:[1,0,0]
    v_pk_fma_f32 v[142:143], v[142:143], v[96:97], v[92:93] op_sel_hi:[1,0,0]
    v_pk_fma_f32 v[144:145], v[144:145], v[96:97], v[92:93] op_sel_hi:[1,0,0]
    v_pk_fma_f32 v[146:147], v[146:147], v[96:97], v[92:93] op_sel_hi:[1,0,0]
    v_pk_mul_f32 v[140:141], v[140:141], v[232:233]
    v_pk_mul_f32 v[142:143], v[142:143], v[234:235]
    v_pk_mul_f32 v[144:145], v[144:145], v[236:237]
    v_pk_mul_f32 v[146:147], v[146:147], v[238:239]
    v_exp_f32 v148, v140
    v_exp_f32 v149, v141
    v_exp_f32 v150, v142
    v_exp_f32 v151, v143
    v_exp_f32 v152, v144
    v_exp_f32 v153, v145
    v_exp_f32 v154, v146
    v_exp_f32 v155, v147
    v_pk_fma_f32 v[148:149], v[148:149], v[62:63], v[62:63] op_sel_hi:[1,0,0]
    v_pk_fma_f32 v[150:151], v[150:151], v[62:63], v[62:63] op_sel_hi:[1,0,0]
    v_pk_fma_f32 v[152:153], v[152:153], v[62:63], v[62:63] op_sel_hi:[1,0,0]
    v_pk_fma_f32 v[154:155], v[154:155], v[62:63], v[62:63] op_sel_hi:[1,0,0]
    v_rcp_f32 v148, v148
    v_rcp_f32 v149, v149
    v_rcp_f32 v150, v150
    v_rcp_f32 v151, v151
    v_rcp_f32 v152, v152
    v_rcp_f32 v153, v153
    v_rcp_f32 v154, v154
    v_rcp_f32 v155, v155
    v_pk_mul_f32 v[148:149], v[148:149], v[232:233]
    v_pk_mul_f32 v[150:151], v[150:151], v[234:235]
    v_pk_mul_f32 v[152:153], v[152:153], v[236:237]
    v_pk_mul_f32 v[154:155], v[154:155], v[238:239]
    v_cvt_pk_bf16_f32 v112, v148, v149
    v_cvt_pk_bf16_f32 v113, v150, v151
    v_cvt_pk_bf16_f32 v114, v152, v153
    v_cvt_pk_bf16_f32 v115, v154, v155
    buffer_store_dwordx4 v[108:111], v105, s[28:31], s61 offen offset:0 sc1
    buffer_store_dwordx4 v[112:115], v105, s[28:31], s61 offen offset:2048 sc1
    v_pk_mul_f32 v[140:141], v[240:241], v[240:241]
    v_pk_mul_f32 v[142:143], v[242:243], v[242:243]
    v_pk_mul_f32 v[144:145], v[244:245], v[244:245]
    v_pk_mul_f32 v[146:147], v[246:247], v[246:247]
    v_pk_fma_f32 v[140:141], v[140:141], v[98:99], v[94:95] op_sel_hi:[1,0,0]
    v_pk_fma_f32 v[142:143], v[142:143], v[98:99], v[94:95] op_sel_hi:[1,0,0]
    v_pk_fma_f32 v[144:145], v[144:145], v[98:99], v[94:95] op_sel_hi:[1,0,0]
    v_pk_fma_f32 v[146:147], v[146:147], v[98:99], v[94:95] op_sel_hi:[1,0,0]
    v_pk_mul_f32 v[140:141], v[140:141], v[240:241]
    v_pk_mul_f32 v[142:143], v[142:143], v[242:243]
    v_pk_mul_f32 v[144:145], v[144:145], v[244:245]
    v_pk_mul_f32 v[146:147], v[146:147], v[246:247]
    v_exp_f32 v148, v140
    v_exp_f32 v149, v141
    v_exp_f32 v150, v142
    v_exp_f32 v151, v143
    v_exp_f32 v152, v144
    v_exp_f32 v153, v145
    v_exp_f32 v154, v146
    v_exp_f32 v155, v147
    v_pk_fma_f32 v[148:149], v[148:149], v[64:65], v[64:65] op_sel_hi:[1,0,0]
    v_pk_fma_f32 v[150:151], v[150:151], v[64:65], v[64:65] op_sel_hi:[1,0,0]
    v_pk_fma_f32 v[152:153], v[152:153], v[64:65], v[64:65] op_sel_hi:[1,0,0]
    v_pk_fma_f32 v[154:155], v[154:155], v[64:65], v[64:65] op_sel_hi:[1,0,0]
    v_rcp_f32 v148, v148
    v_rcp_f32 v149, v149
    v_rcp_f32 v150, v150
    v_rcp_f32 v151, v151
    v_rcp_f32 v152, v152
    v_rcp_f32 v153, v153
    v_rcp_f32 v154, v154
    v_rcp_f32 v155, v155
    v_pk_mul_f32 v[148:149], v[148:149], v[240:241]
    v_pk_mul_f32 v[150:151], v[150:151], v[242:243]
    v_pk_mul_f32 v[152:153], v[152:153], v[244:245]
    v_pk_mul_f32 v[154:155], v[154:155], v[246:247]
    v_cvt_pk_bf16_f32 v116, v148, v149
    v_cvt_pk_bf16_f32 v117, v150, v151
    v_cvt_pk_bf16_f32 v118, v152, v153
    v_cvt_pk_bf16_f32 v119, v154, v155
    v_pk_mul_f32 v[140:141], v[248:249], v[248:249]
    v_pk_mul_f32 v[142:143], v[250:251], v[250:251]
    v_pk_mul_f32 v[144:145], v[252:253], v[252:253]
    v_pk_mul_f32 v[146:147], v[254:255], v[254:255]
    v_pk_fma_f32 v[140:141], v[140:141], v[98:99], v[94:95] op_sel_hi:[1,0,0]
    v_pk_fma_f32 v[142:143], v[142:143], v[98:99], v[94:95] op_sel_hi:[1,0,0]
    v_pk_fma_f32 v[144:145], v[144:145], v[98:99], v[94:95] op_sel_hi:[1,0,0]
    v_pk_fma_f32 v[146:147], v[146:147], v[98:99], v[94:95] op_sel_hi:[1,0,0]
    v_pk_mul_f32 v[140:141], v[140:141], v[248:249]
    v_pk_mul_f32 v[142:143], v[142:143], v[250:251]
    v_pk_mul_f32 v[144:145], v[144:145], v[252:253]
    v_pk_mul_f32 v[146:147], v[146:147], v[254:255]
    v_exp_f32 v148, v140
    v_exp_f32 v149, v141
    v_exp_f32 v150, v142
    v_exp_f32 v151, v143
    v_exp_f32 v152, v144
    v_exp_f32 v153, v145
    v_exp_f32 v154, v146
    v_exp_f32 v155, v147
    v_pk_fma_f32 v[148:149], v[148:149], v[64:65], v[64:65] op_sel_hi:[1,0,0]
    v_pk_fma_f32 v[150:151], v[150:151], v[64:65], v[64:65] op_sel_hi:[1,0,0]
    v_pk_fma_f32 v[152:153], v[152:153], v[64:65], v[64:65] op_sel_hi:[1,0,0]
    v_pk_fma_f32 v[154:155], v[154:155], v[64:65], v[64:65] op_sel_hi:[1,0,0]
    v_rcp_f32 v148, v148
    v_rcp_f32 v149, v149
    v_rcp_f32 v150, v150
    v_rcp_f32 v151, v151
    v_rcp_f32 v152, v152
    v_rcp_f32 v153, v153
    v_rcp_f32 v154, v154
    v_rcp_f32 v155, v155
    v_pk_mul_f32 v[148:149], v[148:149], v[248:249]
    v_pk_mul_f32 v[150:151], v[150:151], v[250:251]
    v_pk_mul_f32 v[152:153], v[152:153], v[252:253]
    v_pk_mul_f32 v[154:155], v[154:155], v[254:255]
    v_cvt_pk_bf16_f32 v120, v148, v149
    v_cvt_pk_bf16_f32 v121, v150, v151
    v_cvt_pk_bf16_f32 v122, v152, v153
    v_cvt_pk_bf16_f32 v123, v154, v155
    buffer_store_dwordx4 v[116:119], v105, s[28:31], s61 offen offset:1024 sc1
    buffer_store_dwordx4 v[120:123], v105, s[28:31], s61 offen offset:3072 sc1
L_B_SKIP2:
    s_sub_u32 s61, s5, 8
    s_lshl_b32 s61, s61, 2
    s_lshl_b32 s44, s51, 1
    s_add_u32 s61, s61, s44
    s_lshl_b32 s61, s61, 11
    s_mul_i32 s44, s60, 65536
    s_add_u32 s61, s61, s44
    s_add_u32 s61, s61, 2097152
    v_pk_mul_f32 v[140:141], v[160:161], v[100:101] op_sel_hi:[1,0]
    v_pk_mul_f32 v[142:143], v[162:163], v[100:101] op_sel_hi:[1,0]
    v_pk_mul_f32 v[144:145], v[164:165], v[100:101] op_sel_hi:[1,0]
    v_pk_mul_f32 v[146:147], v[166:167], v[100:101] op_sel_hi:[1,0]
    v_pk_fma_f32 v[148:149], v[160:161], v[66:67], v[104:105] op_sel_hi:[1,0,0]
    v_pk_fma_f32 v[150:151], v[162:163], v[66:67], v[104:105] op_sel_hi:[1,0,0]
    v_pk_fma_f32 v[152:153], v[164:165], v[66:67], v[104:105] op_sel_hi:[1,0,0]
    v_pk_fma_f32 v[154:155], v[166:167], v[66:67], v[104:105] op_sel_hi:[1,0,0]
    v_exp_f32_e64 v140, v140 clamp
    v_exp_f32_e64 v141, v141 clamp
    v_exp_f32_e64 v142, v142 clamp
    v_exp_f32_e64 v143, v143 clamp
    v_exp_f32_e64 v144, v144 clamp
    v_exp_f32_e64 v145, v145 clamp
    v_exp_f32_e64 v146, v146 clamp
    v_exp_f32_e64 v147, v147 clamp
    v_max_f32 v148, v148, v104
    v_max_f32 v149, v149, v104
    v_max_f32 v150, v150, v104
    v_max_f32 v151, v151, v104
    v_max_f32 v152, v152, v104
    v_max_f32 v153, v153, v104
    v_max_f32 v154, v154, v104
    v_max_f32 v155, v155, v104
    v_pk_add_f32 v[140:141], v[140:141], v[148:149]
    v_pk_add_f32 v[142:143], v[142:143], v[150:151]
    v_pk_add_f32 v[144:145], v[144:145], v[152:153]
    v_pk_add_f32 v[146:147], v[146:147], v[154:155]
    v_cvt_pk_bf16_f32 v108, v140, v141
    v_cvt_pk_bf16_f32 v109, v142, v143
    v_cvt_pk_bf16_f32 v110, v144, v145
    v_cvt_pk_bf16_f32 v111, v146, v147
    v_pk_mul_f32 v[140:141], v[168:169], v[100:101] op_sel_hi:[1,0]
    v_pk_mul_f32 v[142:143], v[170:171], v[100:101] op_sel_hi:[1,0]
    v_pk_mul_f32 v[144:145], v[172:173], v[100:101] op_sel_hi:[1,0]
    v_pk_mul_f32 v[146:147], v[174:175], v[100:101] op_sel_hi:[1,0]
    v_pk_fma_f32 v[148:149], v[168:169], v[66:67], v[104:105] op_sel_hi:[1,0,0]
    v_pk_fma_f32 v[150:151], v[170:171], v[66:67], v[104:105] op_sel_hi:[1,0,0]
    v_pk_fma_f32 v[152:153], v[172:173], v[66:67], v[104:105] op_sel_hi:[1,0,0]
    v_pk_fma_f32 v[154:155], v[174:175], v[66:67], v[104:105] op_sel_hi:[1,0,0]
    v_exp_f32_e64 v140, v140 clamp
    v_exp_f32_e64 v141, v141 clamp
    v_exp_f32_e64 v142, v142 clamp
    v_exp_f32_e64 v143, v143 clamp
    v_exp_f32_e64 v144, v144 clamp
    v_exp_f32_e64 v145, v145 clamp
    v_exp_f32_e64 v146, v146 clamp
    v_exp_f32_e64 v147, v147 clamp
    v_max_f32 v148, v148, v104
    v_max_f32 v149, v149, v104
    v_max_f32 v150, v150, v104
    v_max_f32 v151, v151, v104
    v_max_f32 v152, v152, v104
    v_max_f32 v153, v153, v104
    v_max_f32 v154, v154, v104
    v_max_f32 v155, v155, v104
    v_pk_add_f32 v[140:141], v[140:141], v[148:149]
    v_pk_add_f32 v[142:143], v[142:143], v[150:151]
    v_pk_add_f32 v[144:145], v[144:145], v[152:153]
    v_pk_add_f32 v[146:147], v[146:147], v[154:155]
    v_cvt_pk_bf16_f32 v112, v140, v141
    v_cvt_pk_bf16_f32 v113, v142, v143
    v_cvt_pk_bf16_f32 v114, v144, v145
    v_cvt_pk_bf16_f32 v115, v146, v147
    buffer_store_dwordx4 v[108:111], v105, s[28:31], s61 offen offset:0 sc1
    buffer_store_dwordx4 v[112:115], v105, s[28:31], s61 offen offset:2048 sc1
    v_pk_mul_f32 v[140:141], v[176:177], v[102:103] op_sel_hi:[1,0]
    v_pk_mul_f32 v[142:143], v[178:179], v[102:103] op_sel_hi:[1,0]
    v_pk_mul_f32 v[144:145], v[180:181], v[102:103] op_sel_hi:[1,0]
    v_pk_mul_f32 v[146:147], v[182:183], v[102:103] op_sel_hi:[1,0]
    v_pk_fma_f32 v[148:149], v[176:177], v[68:69], v[104:105] op_sel_hi:[1,0,0]
    v_pk_fma_f32 v[150:151], v[178:179], v[68:69], v[104:105] op_sel_hi:[1,0,0]
    v_pk_fma_f32 v[152:153], v[180:181], v[68:69], v[104:105] op_sel_hi:[1,0,0]
    v_pk_fma_f32 v[154:155], v[182:183], v[68:69], v[104:105] op_sel_hi:[1,0,0]
    v_exp_f32_e64 v140, v140 clamp
    v_exp_f32_e64 v141, v141 clamp
    v_exp_f32_e64 v142, v142 clamp
    v_exp_f32_e64 v143, v143 clamp
    v_exp_f32_e64 v144, v144 clamp
    v_exp_f32_e64 v145, v145 clamp
    v_exp_f32_e64 v146, v146 clamp
    v_exp_f32_e64 v147, v147 clamp
    v_max_f32 v148, v148, v104
    v_max_f32 v149, v149, v104
    v_max_f32 v150, v150, v104
    v_max_f32 v151, v151, v104
    v_max_f32 v152, v152, v104
    v_max_f32 v153, v153, v104
    v_max_f32 v154, v154, v104
    v_max_f32 v155, v155, v104
    v_pk_add_f32 v[140:141], v[140:141], v[148:149]
    v_pk_add_f32 v[142:143], v[142:143], v[150:151]
    v_pk_add_f32 v[144:145], v[144:145], v[152:153]
    v_pk_add_f32 v[146:147], v[146:147], v[154:155]
    v_cvt_pk_bf16_f32 v116, v140, v141
    v_cvt_pk_bf16_f32 v117, v142, v143
    v_cvt_pk_bf16_f32 v118, v144, v145
    v_cvt_pk_bf16_f32 v119, v146, v147
    v_pk_mul_f32 v[140:141], v[184:185], v[102:103] op_sel_hi:[1,0]
    v_pk_mul_f32 v[142:143], v[186:187], v[102:103] op_sel_hi:[1,0]
    v_pk_mul_f32 v[144:145], v[188:189], v[102:103] op_sel_hi:[1,0]
    v_pk_mul_f32 v[146:147], v[190:191], v[102:103] op_sel_hi:[1,0]
    v_pk_fma_f32 v[148:149], v[184:185], v[68:69], v[104:105] op_sel_hi:[1,0,0]
    v_pk_fma_f32 v[150:151], v[186:187], v[68:69], v[104:105] op_sel_hi:[1,0,0]
    v_pk_fma_f32 v[152:153], v[188:189], v[68:69], v[104:105] op_sel_hi:[1,0,0]
    v_pk_fma_f32 v[154:155], v[190:191], v[68:69], v[104:105] op_sel_hi:[1,0,0]
    v_exp_f32_e64 v140, v140 clamp
    v_exp_f32_e64 v141, v141 clamp
    v_exp_f32_e64 v142, v142 clamp
    v_exp_f32_e64 v143, v143 clamp
    v_exp_f32_e64 v144, v144 clamp
    v_exp_f32_e64 v145, v145 clamp
    v_exp_f32_e64 v146, v146 clamp
    v_exp_f32_e64 v147, v147 clamp
    v_max_f32 v148, v148, v104
    v_max_f32 v149, v149, v104
    v_max_f32 v150, v150, v104
    v_max_f32 v151, v151, v104
    v_max_f32 v152, v152, v104
    v_max_f32 v153, v153, v104
    v_max_f32 v154, v154, v104
    v_max_f32 v155, v155, v104
    v_pk_add_f32 v[140:141], v[140:141], v[148:149]
    v_pk_add_f32 v[142:143], v[142:143], v[150:151]
    v_pk_add_f32 v[144:145], v[144:145], v[152:153]
    v_pk_add_f32 v[146:147], v[146:147], v[154:155]
    v_cvt_pk_bf16_f32 v120, v140, v141
    v_cvt_pk_bf16_f32 v121, v142, v143
    v_cvt_pk_bf16_f32 v122, v144, v145
    v_cvt_pk_bf16_f32 v123, v146, v147
    buffer_store_dwordx4 v[116:119], v105, s[28:31], s61 offen offset:1024 sc1
    buffer_store_dwordx4 v[120:123], v105, s[28:31], s61 offen offset:3072 sc1
    s_mov_b64 exec, 1
    ds_add_u32 v8, v9 offset:144
    s_mov_b64 exec, -1
    s_waitcnt vmcnt(4)
    s_lshl_b32 s44, s60, 5
    s_lshl_b32 s45, s5, 1
    s_add_u32 s44, s44, s45
    s_add_u32 s44, s44, s51
    s_mul_i32 s44, s44, 32
    s_add_u32 s44, s44, 4096
    v_mov_b32 v60, s42
    v_mov_b32 v61, s43
    v_mov_b32 v62, 0
    s_mov_b64 exec, 1
    buffer_store_dwordx2 v[60:61], v62, s[28:31], s44 offen sc1
    s_mov_b64 exec, -1
    s_waitcnt vmcnt(1)
    s_lshl_b32 s44, s60, 4
    s_sub_u32 s45, s5, 8
    s_lshl_b32 s45, s45, 1
    s_add_u32 s44, s44, s45
    s_add_u32 s44, s44, s51
    s_mul_i32 s44, s44, 32
    s_add_u32 s44, s44, 36864
    v_mov_b32 v60, s42
    v_mov_b32 v61, s43
    v_mov_b32 v62, 0
    s_mov_b64 exec, 1
    buffer_store_dwordx2 v[60:61], v62, s[28:31], s44 offen sc1
    s_mov_b64 exec, -1
    s_endpgm
L_HELPER:
    s_sub_u32 s49, s3, 4
    s_cmp_lt_u32 s49, 2
    s_cbranch_scc0 L_H_NOTLOADER
    s_mov_b32 s8, s64
    s_and_b32 s9, s65, 0xffff
    s_mov_b32 s10, 2097152
    s_mov_b32 s11, 0x20000
    s_mov_b32 s12, s66
    s_and_b32 s13, s67, 0xffff
    s_mov_b32 s14, 1572864
    s_mov_b32 s15, 0x20000
    s_mov_b32 s16, s72
    s_and_b32 s17, s73, 0xffff
    s_mov_b32 s18, 1409024
    s_mov_b32 s19, 0x20000
    s_cmp_eq_u32 s6, 0
    s_cselect_b32 s20, s12, s16
    s_cselect_b32 s21, s13, s17
    s_cselect_b32 s22, s14, s18
    s_mov_b32 s23, 0x20000
    v_lshrrev_b32 v10, 3, v0
    v_and_b32 v11, 7, v0
    v_lshrrev_b32 v13, 4, v0
    v_xor_b32 v14, v11, v13
    v_lshlrev_b32 v14, 4, v14
    v_lshl_add_u32 v2, v10, 10, v14
    v_xor_b32 v3, 64, v2
    v_bfe_u32 v13, v0, 4, 1
    v_lshlrev_b32 v13, 2, v13
    v_xor_b32 v14, v11, v13
    v_lshlrev_b32 v14, 4, v14
    v_mul_u32_u24 v4, 3072, v10
    v_add_u32 v4, v4, v14
    v_mul_u32_u24 v5, 2752, v10
    v_add_u32 v5, v5, v14
    s_cmp_eq_u32 s6, 0
    s_cselect_b64 vcc, -1, 0
    v_cndmask_b32 v6, v5, v4, vcc
    v_lshrrev_b32 v10, 4, v0
    v_and_b32 v11, 15, v0
    v_lshlrev_b32 v13, 2, v10
    v_xor_b32 v11, v11, v13
    v_lshlrev_b32 v11, 4, v11
    v_mul_u32_u24 v7, 2752, v10
    v_add_u32 v7, v7, v11
    v_mov_b32 v12, 122880
    v_mov_b32 v9, 1
    s_cmp_eq_u32 s6, 0
    s_cbranch_scc0 L_L_TB
    s_lshl_b32 s44, s5, 7
    s_add_u32 s52, s44, 1024
    s_add_u32 s53, s44, 2048
    s_mov_b32 s54, s44
    s_mov_b32 s55, 24576
    s_mov_b32 s56, 196608
    s_branch L_L_TD
L_L_TB:
    s_sub_u32 s44, s5, 8
    s_lshl_b32 s52, s44, 7
    s_lshl_b32 s44, s44, 8
    s_add_u32 s53, s44, 1024
    s_add_u32 s54, s44, 1152
    s_mov_b32 s55, 22016
    s_mov_b32 s56, 176128
L_L_TD:
    s_lshl_b32 s57, s4, 17
    s_mov_b32 s58, 0
    s_mov_b32 s59, 0
    s_sub_u32 s57, s57, 8192
    s_sub_u32 s52, s52, 24576
    s_sub_u32 s53, s53, s55
    s_sub_u32 s54, s54, 22016
    s_cmp_eq_u32 s49, 0
    s_cbranch_scc0 L_LW_START
L_LX_LOOP:
    s_add_u32 s60, s58, s7
    s_and_b32 s60, s60, 7
    s_mov_b32 s51, 0
    s_cmp_lt_u32 s58, 3
    s_cbranch_scc1 L_LX_GO
    s_lshl_b32 s44, s58, 2
    s_add_u32 s44, s44, 122932
    v_mov_b32 v13, s44
    ds_read_b32 v1, v13
    s_cmp_eq_u32 s58, 3
    s_cselect_b32 s47, 6, 4
    s_waitcnt lgkmcnt(0)
    v_readfirstlane_b32 s44, v1
    s_nop 1
    s_cmp_ge_u32 s44, s47
    s_cbranch_scc1 L_LX_GO
    s_waitcnt vmcnt(0)
    s_lshl_b32 s44, s58, 2
    s_add_u32 s44, s44, 122876
    v_mov_b32 v14, s44
    s_mov_b32 s51, 1
    s_mov_b64 exec, 1
    ds_add_u32 v14, v9 offset:0
    s_mov_b64 exec, -1
    s_mov_b32 s45, 0
L_LX_FR_sp:
    ds_read_b32 v1, v13 offset:0
    s_add_u32 s45, s45, 1
    s_waitcnt lgkmcnt(0)
    v_readfirstlane_b32 s44, v1
    s_cmp_ge_u32 s45, 262144
    s_cbranch_scc1 L_LX_FR_ok
    s_cmp_ge_u32 s44, s47
    s_cbranch_scc0 L_LX_FR_sp
L_LX_FR_ok:
L_LX_GO:
    s_lshl_b32 s61, s60, 7
    s_add_u32 s61, s61, s57
    s_mul_i32 s62, s60, 196608
    s_add_u32 s62, s62, s52
    s_mul_i32 s63, s60, s56
    s_add_u32 s63, s63, s53
    s_mul_i32 s48, s60, 176128
    s_add_u32 s48, s48, s54
    s_add_u32 m0, s59, 0
    s_add_u32 s61, s61, 8192
    buffer_load_dwordx4 v2, s[8:11], s61 offen lds
    s_add_u32 m0, s59, 1024
    s_add_u32 s61, s61, 8192
    buffer_load_dwordx4 v3, s[8:11], s61 offen lds
    s_add_u32 m0, s59, 2048
    s_add_u32 s61, s61, 8192
    buffer_load_dwordx4 v2, s[8:11], s61 offen lds
    s_add_u32 m0, s59, 3072
    s_add_u32 s61, s61, 8192
    buffer_load_dwordx4 v3, s[8:11], s61 offen lds
    s_add_u32 m0, s59, 4096
    s_add_u32 s61, s61, 8192
    buffer_load_dwordx4 v2, s[8:11], s61 offen lds
    s_add_u32 m0, s59, 5120
    s_add_u32 s61, s61, 8192
    buffer_load_dwordx4 v3, s[8:11], s61 offen lds
    s_add_u32 m0, s59, 6144
    s_add_u32 s61, s61, 8192
    buffer_load_dwordx4 v2, s[8:11], s61 offen lds
    s_add_u32 m0, s59, 7168
    s_add_u32 s61, s61, 8192
    buffer_load_dwordx4 v3, s[8:11], s61 offen lds
    s_add_u32 m0, s59, 8192
    s_add_u32 s61, s61, 8192
    buffer_load_dwordx4 v2, s[8:11], s61 offen lds
    s_add_u32 m0, s59, 9216
    s_add_u32 s61, s61, 8192
    buffer_load_dwordx4 v3, s[8:11], s61 offen lds
    s_cmp_eq_u32 s58, 0
    s_cbranch_scc1 L_LX_NF
    s_cmp_eq_u32 s51, 1
    s_cbranch_scc1 L_LX_NF
    s_waitcnt vmcnt(10)
    s_lshl_b32 s44, s58, 2
    s_add_u32 s44, s44, 122876
    v_mov_b32 v14, s44
    s_mov_b64 exec, 1
    ds_add_u32 v14, v9 offset:0
    s_mov_b64 exec, -1
L_LX_NF:
    s_add_u32 m0, s59, 10240
    s_add_u32 s61, s61, 8192
    buffer_load_dwordx4 v2, s[8:11], s61 offen lds
    s_add_u32 m0, s59, 11264
    s_add_u32 s61, s61, 8192
    buffer_load_dwordx4 v3, s[8:11], s61 offen lds
    s_add_u32 m0, s59, 12288
    s_add_u32 s61, s61, 8192
    buffer_load_dwordx4 v2, s[8:11], s61 offen lds
    s_add_u32 m0, s59, 13312
    s_add_u32 s61, s61, 8192
    buffer_load_dwordx4 v3, s[8:11], s61 offen lds
    s_add_u32 m0, s59, 14336
    s_add_u32 s61, s61, 8192
    buffer_load_dwordx4 v2, s[8:11], s61 offen lds
    s_add_u32 m0, s59, 15360
    s_add_u32 s61, s61, 8192
    buffer_load_dwordx4 v3, s[8:11], s61 offen lds
    s_add_u32 m0, s59, 16384
    s_add_u32 s62, s62, 24576
    buffer_load_dwordx4 v4, s[12:15], s62 offen lds
    s_add_u32 m0, s59, 17408
    s_add_u32 s62, s62, 24576
    buffer_load_dwordx4 v4, s[12:15], s62 offen lds
    s_add_u32 m0, s59, 18432
    s_add_u32 s62, s62, 24576
    buffer_load_dwordx4 v4, s[12:15], s62 offen lds
    s_add_u32 m0, s59, 19456
    s_add_u32 s62, s62, 24576
    buffer_load_dwordx4 v4, s[12:15], s62 offen lds
    s_cmp_eq_u32 s58, 6
    s_cbranch_scc0 L_LX_NG0
    s_mov_b64 exec, 1
    ds_add_u32 v12, v9 offset:140
    s_mov_b64 exec, -1
L_LX_NG0:
    s_cmp_lg_u32 s58, 0
    s_cbranch_scc1 L_LX_NB
    s_waitcnt lgkmcnt(0)
    s_mul_i32 s44, s42, 0x9E3779B1
    s_mul_i32 s43, s43, 0x85EBCA6B
    s_add_u32 s43, s43, s42
    s_add_u32 s43, s43, 0xC2B2AE35
    s_add_u32 s42, s44, 0x7F4A7C15
    s_barrier
L_LX_NB:
    s_add_u32 s59, s59, 40960
    s_cmp_eq_u32 s59, 122880
    s_cselect_b32 s59, 0, s59
    s_add_u32 s58, s58, 1
    s_cmp_lt_u32 s58, 8
    s_cbranch_scc1 L_LX_LOOP
    s_branch L_L_END
L_LW_START:
    s_cmp_eq_u32 s6, 0
    s_cbranch_scc0 L_LV_START
L_LW_LOOP:
    s_add_u32 s60, s58, s7
    s_and_b32 s60, s60, 7
    s_mov_b32 s51, 0
    s_cmp_lt_u32 s58, 3
    s_cbranch_scc1 L_LW_GO
    s_lshl_b32 s44, s58, 2
    s_add_u32 s44, s44, 122932
    v_mov_b32 v13, s44
    ds_read_b32 v1, v13
    s_cmp_eq_u32 s58, 3
    s_cselect_b32 s47, 6, 4
    s_waitcnt lgkmcnt(0)
    v_readfirstlane_b32 s44, v1
    s_nop 1
    s_cmp_ge_u32 s44, s47
    s_cbranch_scc1 L_LW_GO
    s_waitcnt vmcnt(0)
    s_lshl_b32 s44, s58, 2
    s_add_u32 s44, s44, 122876
    v_mov_b32 v14, s44
    s_mov_b32 s51, 1
    s_mov_b64 exec, 1
    ds_add_u32 v14, v9 offset:0
    s_mov_b64 exec, -1
    s_mov_b32 s45, 0
L_LW_FR_sp:
    ds_read_b32 v1, v13 offset:0
    s_add_u32 s45, s45, 1
    s_waitcnt lgkmcnt(0)
    v_readfirstlane_b32 s44, v1
    s_cmp_ge_u32 s45, 262144
    s_cbranch_scc1 L_LW_FR_ok
    s_cmp_ge_u32 s44, s47
    s_cbranch_scc0 L_LW_FR_sp
L_LW_FR_ok:
L_LW_GO:
    s_lshl_b32 s61, s60, 7
    s_add_u32 s61, s61, s57
    s_mul_i32 s62, s60, 196608
    s_add_u32 s62, s62, s52
    s_mul_i32 s63, s60, s56
    s_add_u32 s63, s63, s53
    s_mul_i32 s48, s60, 176128
    s_add_u32 s48, s48, s54
    s_add_u32 s62, s62, 98304
    s_add_u32 m0, s59, 24576
    s_add_u32 s63, s63, s55
    buffer_load_dwordx4 v6, s[20:23], s63 offen lds
    s_add_u32 m0, s59, 32768
    s_add_u32 s48, s48, 22016
    buffer_load_dwordx4 v5, s[16:19], s48 offen lds
    s_add_u32 m0, s59, 25600
    s_add_u32 s63, s63, s55
    buffer_load_dwordx4 v6, s[20:23], s63 offen lds
    s_add_u32 m0, s59, 33792
    s_add_u32 s48, s48, 22016
    buffer_load_dwordx4 v5, s[16:19], s48 offen lds
    s_add_u32 m0, s59, 20480
    s_add_u32 s62, s62, 24576
    buffer_load_dwordx4 v4, s[12:15], s62 offen lds
    s_add_u32 m0, s59, 26624
    s_add_u32 s63, s63, s55
    buffer_load_dwordx4 v6, s[20:23], s63 offen lds
    s_add_u32 m0, s59, 34816
    s_add_u32 s48, s48, 22016
    buffer_load_dwordx4 v5, s[16:19], s48 offen lds
    s_add_u32 m0, s59, 27648
    s_add_u32 s63, s63, s55
    buffer_load_dwordx4 v6, s[20:23], s63 offen lds
    s_add_u32 m0, s59, 35840
    s_add_u32 s48, s48, 22016
    buffer_load_dwordx4 v5, s[16:19], s48 offen lds
    s_add_u32 m0, s59, 21504
    s_add_u32 s62, s62, 24576
    buffer_load_dwordx4 v4, s[12:15], s62 offen lds
    s_cmp_eq_u32 s58, 0
    s_cbranch_scc1 L_LW_NF
    s_cmp_eq_u32 s51, 1
    s_cbranch_scc1 L_LW_NF
    s_waitcnt vmcnt(10)
    s_lshl_b32 s44, s58, 2
    s_add_u32 s44, s44, 122876
    v_mov_b32 v14, s44
    s_mov_b64 exec, 1
    ds_add_u32 v14, v9 offset:0
    s_mov_b64 exec, -1
L_LW_NF:
    s_add_u32 m0, s59, 28672
    s_add_u32 s63, s63, s55
    buffer_load_dwordx4 v6, s[20:23], s63 offen lds
    s_add_u32 m0, s59, 36864
    s_add_u32 s48, s48, 22016
    buffer_load_dwordx4 v5, s[16:19], s48 offen lds
    s_add_u32 m0, s59, 29696
    s_add_u32 s63, s63, s55
    buffer_load_dwordx4 v6, s[20:23], s63 offen lds
    s_add_u32 m0, s59, 37888
    s_add_u32 s48, s48, 22016
    buffer_load_dwordx4 v5, s[16:19], s48 offen lds
    s_add_u32 m0, s59, 22528
    s_add_u32 s62, s62, 24576
    buffer_load_dwordx4 v4, s[12:15], s62 offen lds
    s_add_u32 m0, s59, 30720
    s_add_u32 s63, s63, s55
    buffer_load_dwordx4 v6, s[20:23], s63 offen lds
    s_add_u32 m0, s59, 38912
    s_add_u32 s48, s48, 22016
    buffer_load_dwordx4 v5, s[16:19], s48 offen lds
    s_add_u32 m0, s59, 31744
    s_add_u32 s63, s63, s55
    buffer_load_dwordx4 v6, s[20:23], s63 offen lds
    s_add_u32 m0, s59, 39936
    s_add_u32 s48, s48, 22016
    buffer_load_dwordx4 v5, s[16:19], s48 offen lds
    s_add_u32 m0, s59, 23552
    s_add_u32 s62, s62, 24576
    buffer_load_dwordx4 v4, s[12:15], s62 offen lds
    s_cmp_lg_u32 s58, 0
    s_cbranch_scc1 L_LW_NB
    s_waitcnt lgkmcnt(0)
    s_mul_i32 s44, s42, 0x9E3779B1
    s_mul_i32 s43, s43, 0x85EBCA6B
    s_add_u32 s43, s43, s42
    s_add_u32 s43, s43, 0xC2B2AE35
    s_add_u32 s42, s44, 0x7F4A7C15
    s_barrier
L_LW_NB:
    s_add_u32 s59, s59, 40960
    s_cmp_eq_u32 s59, 122880
    s_cselect_b32 s59, 0, s59
    s_add_u32 s58, s58, 1
    s_cmp_lt_u32 s58, 8
    s_cbranch_scc1 L_LW_LOOP
    s_branch L_L_END
L_LV_START:
L_LV_LOOP:
    s_add_u32 s60, s58, s7
    s_and_b32 s60, s60, 7
    s_mov_b32 s51, 0
    s_cmp_lt_u32 s58, 3
    s_cbranch_scc1 L_LV_GO
    s_lshl_b32 s44, s58, 2
    s_add_u32 s44, s44, 122932
    v_mov_b32 v13, s44
    ds_read_b32 v1, v13
    s_cmp_eq_u32 s58, 3
    s_cselect_b32 s47, 6, 4
    s_waitcnt lgkmcnt(0)
    v_readfirstlane_b32 s44, v1
    s_nop 1
    s_cmp_ge_u32 s44, s47
    s_cbranch_scc1 L_LV_GO
    s_waitcnt vmcnt(0)
    s_lshl_b32 s44, s58, 2
    s_add_u32 s44, s44, 122876
    v_mov_b32 v14, s44
    s_mov_b32 s51, 1
    s_mov_b64 exec, 1
    ds_add_u32 v14, v9 offset:0
    s_mov_b64 exec, -1
    s_mov_b32 s45, 0
L_LV_FR_sp:
    ds_read_b32 v1, v13 offset:0
    s_add_u32 s45, s45, 1
    s_waitcnt lgkmcnt(0)
    v_readfirstlane_b32 s44, v1
    s_cmp_ge_u32 s45, 262144
    s_cbranch_scc1 L_LV_FR_ok
    s_cmp_ge_u32 s44, s47
    s_cbranch_scc0 L_LV_FR_sp
L_LV_FR_ok:
L_LV_GO:
    s_lshl_b32 s61, s60, 7
    s_add_u32 s61, s61, s57
    s_mul_i32 s62, s60, 196608
    s_add_u32 s62, s62, s52
    s_mul_i32 s63, s60, s56
    s_add_u32 s63, s63, s53
    s_mul_i32 s48, s60, 176128
    s_add_u32 s48, s48, s54
    s_add_u32 s62, s62, 98304
    s_add_u32 s63, s63, 11008
    s_add_u32 m0, s59, 24576
    s_add_u32 s63, s63, 11008
    buffer_load_dwordx4 v7, s[16:19], s63 offen lds
    s_add_u32 m0, s59, 25600
    s_add_u32 s63, s63, 11008
    buffer_load_dwordx4 v7, s[16:19], s63 offen lds
    s_add_u32 m0, s59, 26624
    s_add_u32 s63, s63, 11008
    buffer_load_dwordx4 v7, s[16:19], s63 offen lds
    s_add_u32 m0, s59, 27648
    s_add_u32 s63, s63, 11008
    buffer_load_dwordx4 v7, s[16:19], s63 offen lds
    s_add_u32 m0, s59, 20480
    s_add_u32 s62, s62, 24576
    buffer_load_dwordx4 v4, s[12:15], s62 offen lds
    s_add_u32 m0, s59, 28672
    s_add_u32 s63, s63, 11008
    buffer_load_dwordx4 v7, s[16:19], s63 offen lds
    s_add_u32 m0, s59, 29696
    s_add_u32 s63, s63, 11008
    buffer_load_dwordx4 v7, s[16:19], s63 offen lds
    s_add_u32 m0, s59, 30720
    s_add_u32 s63, s63, 11008
    buffer_load_dwordx4 v7, s[16:19], s63 offen lds
    s_add_u32 m0, s59, 31744
    s_add_u32 s63, s63, 11008
    buffer_load_dwordx4 v7, s[16:19], s63 offen lds
    s_add_u32 m0, s59, 21504
    s_add_u32 s62, s62, 24576
    buffer_load_dwordx4 v4, s[12:15], s62 offen lds
    s_cmp_eq_u32 s58, 0
    s_cbranch_scc1 L_LV_NF
    s_cmp_eq_u32 s51, 1
    s_cbranch_scc1 L_LV_NF
    s_waitcnt vmcnt(10)
    s_lshl_b32 s44, s58, 2
    s_add_u32 s44, s44, 122876
    v_mov_b32 v14, s44
    s_mov_b64 exec, 1
    ds_add_u32 v14, v9 offset:0
    s_mov_b64 exec, -1
L_LV_NF:
    s_add_u32 m0, s59, 32768
    s_add_u32 s63, s63, 11008
    buffer_load_dwordx4 v7, s[16:19], s63 offen lds
    s_add_u32 m0, s59, 33792
    s_add_u32 s63, s63, 11008
    buffer_load_dwordx4 v7, s[16:19], s63 offen lds
    s_add_u32 m0, s59, 34816
    s_add_u32 s63, s63, 11008
    buffer_load_dwordx4 v7, s[16:19], s63 offen lds
    s_add_u32 m0, s59, 35840
    s_add_u32 s63, s63, 11008
    buffer_load_dwordx4 v7, s[16:19], s63 offen lds
    s_add_u32 m0, s59, 22528
    s_add_u32 s62, s62, 24576
    buffer_load_dwordx4 v4, s[12:15], s62 offen lds
    s_add_u32 m0, s59, 36864
    s_add_u32 s63, s63, 11008
    buffer_load_dwordx4 v7, s[16:19], s63 offen lds
    s_add_u32 m0, s59, 37888
    s_add_u32 s63, s63, 11008
    buffer_load_dwordx4 v7, s[16:19], s63 offen lds
    s_add_u32 m0, s59, 38912
    s_add_u32 s63, s63, 11008
    buffer_load_dwordx4 v7, s[16:19], s63 offen lds
    s_add_u32 m0, s59, 39936
    s_add_u32 s63, s63, 11008
    buffer_load_dwordx4 v7, s[16:19], s63 offen lds
    s_add_u32 m0, s59, 23552
    s_add_u32 s62, s62, 24576
    buffer_load_dwordx4 v4, s[12:15], s62 offen lds
    s_cmp_lg_u32 s58, 0
    s_cbranch_scc1 L_LV_NB
    s_waitcnt lgkmcnt(0)
    s_mul_i32 s44, s42, 0x9E3779B1
    s_mul_i32 s43, s43, 0x85EBCA6B
    s_add_u32 s43, s43, s42
    s_add_u32 s43, s43, 0xC2B2AE35
    s_add_u32 s42, s44, 0x7F4A7C15
    s_barrier
L_LV_NB:
    s_add_u32 s59, s59, 40960
    s_cmp_eq_u32 s59, 122880
    s_cselect_b32 s59, 0, s59
    s_add_u32 s58, s58, 1
    s_cmp_lt_u32 s58, 8
    s_cbranch_scc1 L_LV_LOOP
L_L_END:
    s_mov_b64 exec, 1
    ds_add_u32 v12, v9 offset:128
    s_mov_b64 exec, -1
    s_waitcnt vmcnt(0)
    s_mov_b64 exec, 1
    ds_add_u32 v12, v9 offset:28
    s_mov_b64 exec, -1
    s_mov_b32 s45, 0
L_L_GI_sp:
    ds_read_b32 v1, v12 offset:136
    s_add_u32 s45, s45, 1
    s_waitcnt lgkmcnt(0)
    v_readfirstlane_b32 s44, v1
    s_cmp_ge_u32 s45, 262144
    s_cbranch_scc1 L_L_GI_ok
    s_cmp_ge_u32 s44, 1
    s_cbranch_scc0 L_L_GI_sp
L_L_GI_ok:
    s_branch L_H_B
L_H_NOTLOADER:
    s_waitcnt lgkmcnt(0)
    s_mul_i32 s44, s42, 0x9E3779B1
    s_mul_i32 s43, s43, 0x85EBCA6B
    s_add_u32 s43, s43, s42
    s_add_u32 s43, s43, 0xC2B2AE35
    s_add_u32 s42, s44, 0x7F4A7C15
    s_barrier
    v_mov_b32 v12, 122880
    v_mov_b32 v9, 1
    s_mov_b32 s45, 0
L_H_F0_sp:
    ds_read_b32 v1, v12 offset:0
    s_add_u32 s45, s45, 1
    s_waitcnt lgkmcnt(0)
    v_readfirstlane_b32 s44, v1
    s_cmp_ge_u32 s45, 262144
    s_cbranch_scc1 L_H_F0_ok
    s_cmp_ge_u32 s44, 2
    s_cbranch_scc0 L_H_F0_sp
L_H_F0_ok:
    s_cmp_eq_u32 s49, 2
    s_cbranch_scc0 L_H_COL
    v_bfe_u32 v10, v0, 1, 3
    v_lshlrev_b32 v10, 4, v10
    v_lshl_add_u32 v10, v0, 7, v10
    v_xor_b32 v11, 0, v10
    ds_read_b128 v[16:19], v11
    ds_read_b128 v[48:51], v11 offset:8192
    v_xor_b32 v11, 16, v10
    ds_read_b128 v[20:23], v11
    ds_read_b128 v[52:55], v11 offset:8192
    v_xor_b32 v11, 32, v10
    ds_read_b128 v[24:27], v11
    ds_read_b128 v[56:59], v11 offset:8192
    v_xor_b32 v11, 48, v10
    ds_read_b128 v[28:31], v11
    ds_read_b128 v[60:63], v11 offset:8192
    v_xor_b32 v11, 64, v10
    ds_read_b128 v[32:35], v11
    ds_read_b128 v[64:67], v11 offset:8192
    v_xor_b32 v11, 80, v10
    ds_read_b128 v[36:39], v11
    ds_read_b128 v[68:71], v11 offset:8192
    s_waitcnt lgkmcnt(6)
    v_xor_b32 v11, 96, v10
    ds_read_b128 v[40:43], v11
    ds_read_b128 v[72:75], v11 offset:8192
    v_xor_b32 v11, 112, v10
    ds_read_b128 v[44:47], v11
    ds_read_b128 v[76:79], v11 offset:8192
    s_waitcnt lgkmcnt(0)
    s_mov_b64 exec, 1
    ds_add_u32 v12, v9 offset:64
    s_mov_b64 exec, -1
    s_mov_b32 s46, 0xffff0000
    v_mov_b32 v80, 0
    v_mov_b32 v81, 0
    v_mov_b32 v82, 0
    v_mov_b32 v83, 0
    v_mov_b32 v84, 0
    v_mov_b32 v85, 0
    v_mov_b32 v86, 0
    v_mov_b32 v87, 0
    v_lshlrev_b32 v88, 16, v16
    v_and_b32 v89, s46, v16
    v_add_f32 v80, v80, v88
    v_add_f32 v81, v81, v89
    v_fmac_f32 v82, v88, v88
    v_fmac_f32 v83, v89, v89
    v_lshlrev_b32 v90, 16, v48
    v_and_b32 v91, s46, v48
    v_add_f32 v84, v84, v90
    v_add_f32 v85, v85, v91
    v_fmac_f32 v86, v90, v90
    v_fmac_f32 v87, v91, v91
    v_lshlrev_b32 v88, 16, v17
    v_and_b32 v89, s46, v17
    v_add_f32 v80, v80, v88
    v_add_f32 v81, v81, v89
    v_fmac_f32 v82, v88, v88
    v_fmac_f32 v83, v89, v89
    v_lshlrev_b32 v90, 16, v49
    v_and_b32 v91, s46, v49
    v_add_f32 v84, v84, v90
    v_add_f32 v85, v85, v91
    v_fmac_f32 v86, v90, v90
    v_fmac_f32 v87, v91, v91
    v_lshlrev_b32 v88, 16, v18
    v_and_b32 v89, s46, v18
    v_add_f32 v80, v80, v88
    v_add_f32 v81, v81, v89
    v_fmac_f32 v82, v88, v88
    v_fmac_f32 v83, v89, v89
    v_lshlrev_b32 v90, 16, v50
    v_and_b32 v91, s46, v50
    v_add_f32 v84, v84, v90
    v_add_f32 v85, v85, v91
    v_fmac_f32 v86, v90, v90
    v_fmac_f32 v87, v91, v91
    v_lshlrev_b32 v88, 16, v19
    v_and_b32 v89, s46, v19
    v_add_f32 v80, v80, v88
    v_add_f32 v81, v81, v89
    v_fmac_f32 v82, v88, v88
    v_fmac_f32 v83, v89, v89
    v_lshlrev_b32 v90, 16, v51
    v_and_b32 v91, s46, v51
    v_add_f32 v84, v84, v90
    v_add_f32 v85, v85, v91
    v_fmac_f32 v86, v90, v90
    v_fmac_f32 v87, v91, v91
    v_lshlrev_b32 v88, 16, v20
    v_and_b32 v89, s46, v20
    v_add_f32 v80, v80, v88
    v_add_f32 v81, v81, v89
    v_fmac_f32 v82, v88, v88
    v_fmac_f32 v83, v89, v89
    v_lshlrev_b32 v90, 16, v52
    v_and_b32 v91, s46, v52
    v_add_f32 v84, v84, v90
    v_add_f32 v85, v85, v91
    v_fmac_f32 v86, v90, v90
    v_fmac_f32 v87, v91, v91
    v_lshlrev_b32 v88, 16, v21
    v_and_b32 v89, s46, v21
    v_add_f32 v80, v80, v88
    v_add_f32 v81, v81, v89
    v_fmac_f32 v82, v88, v88
    v_fmac_f32 v83, v89, v89
    v_lshlrev_b32 v90, 16, v53
    v_and_b32 v91, s46, v53
    v_add_f32 v84, v84, v90
    v_add_f32 v85, v85, v91
    v_fmac_f32 v86, v90, v90
    v_fmac_f32 v87, v91, v91
    v_lshlrev_b32 v88, 16, v22
    v_and_b32 v89, s46, v22
    v_add_f32 v80, v80, v88
    v_add_f32 v81, v81, v89
    v_fmac_f32 v82, v88, v88
    v_fmac_f32 v83, v89, v89
    v_lshlrev_b32 v90, 16, v54
    v_and_b32 v91, s46, v54
    v_add_f32 v84, v84, v90
    v_add_f32 v85, v85, v91
    v_fmac_f32 v86, v90, v90
    v_fmac_f32 v87, v91, v91
    v_lshlrev_b32 v88, 16, v23
    v_and_b32 v89, s46, v23
    v_add_f32 v80, v80, v88
    v_add_f32 v81, v81, v89
    v_fmac_f32 v82, v88, v88
    v_fmac_f32 v83, v89, v89
    v_lshlrev_b32 v90, 16, v55
    v_and_b32 v91, s46, v55
    v_add_f32 v84, v84, v90
    v_add_f32 v85, v85, v91
    v_fmac_f32 v86, v90, v90
    v_fmac_f32 v87, v91, v91
    v_lshlrev_b32 v88, 16, v24
    v_and_b32 v89, s46, v24
    v_add_f32 v80, v80, v88
    v_add_f32 v81, v81, v89
    v_fmac_f32 v82, v88, v88
    v_fmac_f32 v83, v89, v89
    v_lshlrev_b32 v90, 16, v56
    v_and_b32 v91, s46, v56
    v_add_f32 v84, v84, v90
    v_add_f32 v85, v85, v91
    v_fmac_f32 v86, v90, v90
    v_fmac_f32 v87, v91, v91
    v_lshlrev_b32 v88, 16, v25
    v_and_b32 v89, s46, v25
    v_add_f32 v80, v80, v88
    v_add_f32 v81, v81, v89
    v_fmac_f32 v82, v88, v88
    v_fmac_f32 v83, v89, v89
    v_lshlrev_b32 v90, 16, v57
    v_and_b32 v91, s46, v57
    v_add_f32 v84, v84, v90
    v_add_f32 v85, v85, v91
    v_fmac_f32 v86, v90, v90
    v_fmac_f32 v87, v91, v91
    v_lshlrev_b32 v88, 16, v26
    v_and_b32 v89, s46, v26
    v_add_f32 v80, v80, v88
    v_add_f32 v81, v81, v89
    v_fmac_f32 v82, v88, v88
    v_fmac_f32 v83, v89, v89
    v_lshlrev_b32 v90, 16, v58
    v_and_b32 v91, s46, v58
    v_add_f32 v84, v84, v90
    v_add_f32 v85, v85, v91
    v_fmac_f32 v86, v90, v90
    v_fmac_f32 v87, v91, v91
    v_lshlrev_b32 v88, 16, v27
    v_and_b32 v89, s46, v27
    v_add_f32 v80, v80, v88
    v_add_f32 v81, v81, v89
    v_fmac_f32 v82, v88, v88
    v_fmac_f32 v83, v89, v89
    v_lshlrev_b32 v90, 16, v59
    v_and_b32 v91, s46, v59
    v_add_f32 v84, v84, v90
    v_add_f32 v85, v85, v91
    v_fmac_f32 v86, v90, v90
    v_fmac_f32 v87, v91, v91
    v_lshlrev_b32 v88, 16, v28
    v_and_b32 v89, s46, v28
    v_add_f32 v80, v80, v88
    v_add_f32 v81, v81, v89
    v_fmac_f32 v82, v88, v88
    v_fmac_f32 v83, v89, v89
    v_lshlrev_b32 v90, 16, v60
    v_and_b32 v91, s46, v60
    v_add_f32 v84, v84, v90
    v_add_f32 v85, v85, v91
    v_fmac_f32 v86, v90, v90
    v_fmac_f32 v87, v91, v91
    v_lshlrev_b32 v88, 16, v29
    v_and_b32 v89, s46, v29
    v_add_f32 v80, v80, v88
    v_add_f32 v81, v81, v89
    v_fmac_f32 v82, v88, v88
    v_fmac_f32 v83, v89, v89
    v_lshlrev_b32 v90, 16, v61
    v_and_b32 v91, s46, v61
    v_add_f32 v84, v84, v90
    v_add_f32 v85, v85, v91
    v_fmac_f32 v86, v90, v90
    v_fmac_f32 v87, v91, v91
    v_lshlrev_b32 v88, 16, v30
    v_and_b32 v89, s46, v30
    v_add_f32 v80, v80, v88
    v_add_f32 v81, v81, v89
    v_fmac_f32 v82, v88, v88
    v_fmac_f32 v83, v89, v89
    v_lshlrev_b32 v90, 16, v62
    v_and_b32 v91, s46, v62
    v_add_f32 v84, v84, v90
    v_add_f32 v85, v85, v91
    v_fmac_f32 v86, v90, v90
    v_fmac_f32 v87, v91, v91
    v_lshlrev_b32 v88, 16, v31
    v_and_b32 v89, s46, v31
    v_add_f32 v80, v80, v88
    v_add_f32 v81, v81, v89
    v_fmac_f32 v82, v88, v88
    v_fmac_f32 v83, v89, v89
    v_lshlrev_b32 v90, 16, v63
    v_and_b32 v91, s46, v63
    v_add_f32 v84, v84, v90
    v_add_f32 v85, v85, v91
    v_fmac_f32 v86, v90, v90
    v_fmac_f32 v87, v91, v91
    v_lshlrev_b32 v88, 16, v32
    v_and_b32 v89, s46, v32
    v_add_f32 v80, v80, v88
    v_add_f32 v81, v81, v89
    v_fmac_f32 v82, v88, v88
    v_fmac_f32 v83, v89, v89
    v_lshlrev_b32 v90, 16, v64
    v_and_b32 v91, s46, v64
    v_add_f32 v84, v84, v90
    v_add_f32 v85, v85, v91
    v_fmac_f32 v86, v90, v90
    v_fmac_f32 v87, v91, v91
    v_lshlrev_b32 v88, 16, v33
    v_and_b32 v89, s46, v33
    v_add_f32 v80, v80, v88
    v_add_f32 v81, v81, v89
    v_fmac_f32 v82, v88, v88
    v_fmac_f32 v83, v89, v89
    v_lshlrev_b32 v90, 16, v65
    v_and_b32 v91, s46, v65
    v_add_f32 v84, v84, v90
    v_add_f32 v85, v85, v91
    v_fmac_f32 v86, v90, v90
    v_fmac_f32 v87, v91, v91
    v_lshlrev_b32 v88, 16, v34
    v_and_b32 v89, s46, v34
    v_add_f32 v80, v80, v88
    v_add_f32 v81, v81, v89
    v_fmac_f32 v82, v88, v88
    v_fmac_f32 v83, v89, v89
    v_lshlrev_b32 v90, 16, v66
    v_and_b32 v91, s46, v66
    v_add_f32 v84, v84, v90
    v_add_f32 v85, v85, v91
    v_fmac_f32 v86, v90, v90
    v_fmac_f32 v87, v91, v91
    v_lshlrev_b32 v88, 16, v35
    v_and_b32 v89, s46, v35
    v_add_f32 v80, v80, v88
    v_add_f32 v81, v81, v89
    v_fmac_f32 v82, v88, v88
    v_fmac_f32 v83, v89, v89
    v_lshlrev_b32 v90, 16, v67
    v_and_b32 v91, s46, v67
    v_add_f32 v84, v84, v90
    v_add_f32 v85, v85, v91
    v_fmac_f32 v86, v90, v90
    v_fmac_f32 v87, v91, v91
    v_lshlrev_b32 v88, 16, v36
    v_and_b32 v89, s46, v36
    v_add_f32 v80, v80, v88
    v_add_f32 v81, v81, v89
    v_fmac_f32 v82, v88, v88
    v_fmac_f32 v83, v89, v89
    v_lshlrev_b32 v90, 16, v68
    v_and_b32 v91, s46, v68
    v_add_f32 v84, v84, v90
    v_add_f32 v85, v85, v91
    v_fmac_f32 v86, v90, v90
    v_fmac_f32 v87, v91, v91
    v_lshlrev_b32 v88, 16, v37
    v_and_b32 v89, s46, v37
    v_add_f32 v80, v80, v88
    v_add_f32 v81, v81, v89
    v_fmac_f32 v82, v88, v88
    v_fmac_f32 v83, v89, v89
    v_lshlrev_b32 v90, 16, v69
    v_and_b32 v91, s46, v69
    v_add_f32 v84, v84, v90
    v_add_f32 v85, v85, v91
    v_fmac_f32 v86, v90, v90
    v_fmac_f32 v87, v91, v91
    v_lshlrev_b32 v88, 16, v38
    v_and_b32 v89, s46, v38
    v_add_f32 v80, v80, v88
    v_add_f32 v81, v81, v89
    v_fmac_f32 v82, v88, v88
    v_fmac_f32 v83, v89, v89
    v_lshlrev_b32 v90, 16, v70
    v_and_b32 v91, s46, v70
    v_add_f32 v84, v84, v90
    v_add_f32 v85, v85, v91
    v_fmac_f32 v86, v90, v90
    v_fmac_f32 v87, v91, v91
    v_lshlrev_b32 v88, 16, v39
    v_and_b32 v89, s46, v39
    v_add_f32 v80, v80, v88
    v_add_f32 v81, v81, v89
    v_fmac_f32 v82, v88, v88
    v_fmac_f32 v83, v89, v89
    v_lshlrev_b32 v90, 16, v71
    v_and_b32 v91, s46, v71
    v_add_f32 v84, v84, v90
    v_add_f32 v85, v85, v91
    v_fmac_f32 v86, v90, v90
    v_fmac_f32 v87, v91, v91
    v_lshlrev_b32 v88, 16, v40
    v_and_b32 v89, s46, v40
    v_add_f32 v80, v80, v88
    v_add_f32 v81, v81, v89
    v_fmac_f32 v82, v88, v88
    v_fmac_f32 v83, v89, v89
    v_lshlrev_b32 v90, 16, v72
    v_and_b32 v91, s46, v72
    v_add_f32 v84, v84, v90
    v_add_f32 v85, v85, v91
    v_fmac_f32 v86, v90, v90
    v_fmac_f32 v87, v91, v91
    v_lshlrev_b32 v88, 16, v41
    v_and_b32 v89, s46, v41
    v_add_f32 v80, v80, v88
    v_add_f32 v81, v81, v89
    v_fmac_f32 v82, v88, v88
    v_fmac_f32 v83, v89, v89
    v_lshlrev_b32 v90, 16, v73
    v_and_b32 v91, s46, v73
    v_add_f32 v84, v84, v90
    v_add_f32 v85, v85, v91
    v_fmac_f32 v86, v90, v90
    v_fmac_f32 v87, v91, v91
    v_lshlrev_b32 v88, 16, v42
    v_and_b32 v89, s46, v42
    v_add_f32 v80, v80, v88
    v_add_f32 v81, v81, v89
    v_fmac_f32 v82, v88, v88
    v_fmac_f32 v83, v89, v89
    v_lshlrev_b32 v90, 16, v74
    v_and_b32 v91, s46, v74
    v_add_f32 v84, v84, v90
    v_add_f32 v85, v85, v91
    v_fmac_f32 v86, v90, v90
    v_fmac_f32 v87, v91, v91
    v_lshlrev_b32 v88, 16, v43
    v_and_b32 v89, s46, v43
    v_add_f32 v80, v80, v88
    v_add_f32 v81, v81, v89
    v_fmac_f32 v82, v88, v88
    v_fmac_f32 v83, v89, v89
    v_lshlrev_b32 v90, 16, v75
    v_and_b32 v91, s46, v75
    v_add_f32 v84, v84, v90
    v_add_f32 v85, v85, v91
    v_fmac_f32 v86, v90, v90
    v_fmac_f32 v87, v91, v91
    v_lshlrev_b32 v88, 16, v44
    v_and_b32 v89, s46, v44
    v_add_f32 v80, v80, v88
    v_add_f32 v81, v81, v89
    v_fmac_f32 v82, v88, v88
    v_fmac_f32 v83, v89, v89
    v_lshlrev_b32 v90, 16, v76
    v_and_b32 v91, s46, v76
    v_add_f32 v84, v84, v90
    v_add_f32 v85, v85, v91
    v_fmac_f32 v86, v90, v90
    v_fmac_f32 v87, v91, v91
    v_lshlrev_b32 v88, 16, v45
    v_and_b32 v89, s46, v45
    v_add_f32 v80, v80, v88
    v_add_f32 v81, v81, v89
    v_fmac_f32 v82, v88, v88
    v_fmac_f32 v83, v89, v89
    v_lshlrev_b32 v90, 16, v77
    v_and_b32 v91, s46, v77
    v_add_f32 v84, v84, v90
    v_add_f32 v85, v85, v91
    v_fmac_f32 v86, v90, v90
    v_fmac_f32 v87, v91, v91
    v_lshlrev_b32 v88, 16, v46
    v_and_b32 v89, s46, v46
    v_add_f32 v80, v80, v88
    v_add_f32 v81, v81, v89
    v_fmac_f32 v82, v88, v88
    v_fmac_f32 v83, v89, v89
    v_lshlrev_b32 v90, 16, v78
    v_and_b32 v91, s46, v78
    v_add_f32 v84, v84, v90
    v_add_f32 v85, v85, v91
    v_fmac_f32 v86, v90, v90
    v_fmac_f32 v87, v91, v91
    v_lshlrev_b32 v88, 16, v47
    v_and_b32 v89, s46, v47
    v_add_f32 v80, v80, v88
    v_add_f32 v81, v81, v89
    v_fmac_f32 v82, v88, v88
    v_fmac_f32 v83, v89, v89
    v_lshlrev_b32 v90, 16, v79
    v_and_b32 v91, s46, v79
    v_add_f32 v84, v84, v90
    v_add_f32 v85, v85, v91
    v_fmac_f32 v86, v90, v90
    v_fmac_f32 v87, v91, v91
    v_add_f32 v92, v80, v81
    v_add_f32 v93, v82, v83
    v_mov_b32 v94, s42
    v_mov_b32 v95, s43
    v_add_f32 v96, v84, v85
    v_add_f32 v97, v86, v87
    v_mov_b32 v98, s42
    v_mov_b32 v99, s43
    s_and_b32 s44, s2, 3
    s_cmp_lt_u32 s44, 2
    s_cbranch_scc0 L_SR_NOPUB
    s_lshl_b32 s44, s4, 3
    s_add_u32 s44, s44, s7
    s_lshl_b32 s44, s44, 11
    s_add_u32 s44, s44, 1310720
    v_lshlrev_b32 v11, 4, v0
    buffer_store_dwordx4 v[92:95], v11, s[28:31], s44 offen sc1
    buffer_store_dwordx4 v[96:99], v11, s[28:31], s44 offen offset:1024 sc1
L_SR_NOPUB:
    s_mov_b32 s36, s74
    s_and_b32 s37, s75, 0xffff
    s_mov_b32 s38, 2752
    s_mov_b32 s39, 0x20000
    v_and_b32 v10, 31, v0
    v_lshlrev_b32 v10, 1, v10
    v_lshrrev_b32 v13, 5, v0
    v_mul_u32_u24 v13, 3, v13
    s_cmp_eq_u32 s6, 0
    s_cbranch_scc0 L_SR_TB
    s_lshl_b32 s44, s5, 1
    s_sub_u32 s44, s44, 4
    s_mov_b32 s45, 4
    s_branch L_SR_TD
L_SR_TB:
    s_sub_u32 s44, s5, 8
    s_lshl_b32 s44, s44, 2
    s_add_u32 s44, s44, 14
    s_mov_b32 s45, 2
L_SR_TD:
    v_mov_b32 v45, 0x7ffffff0
    v_add_u32 v14, 0, v13
    v_cmp_le_u32 vcc, s45, v14
    v_add_u32 v14, s44, v14
    v_lshl_add_u32 v14, v14, 6, v10
    v_cndmask_b32 v14, v45, v14, vcc
    buffer_load_ushort v112, v14, s[36:39], 0 offen
    v_add_u32 v14, 1, v13
    v_cmp_le_u32 vcc, s45, v14
    v_add_u32 v14, s44, v14
    v_lshl_add_u32 v14, v14, 6, v10
    v_cndmask_b32 v14, v45, v14, vcc
    buffer_load_ushort v113, v14, s[36:39], 0 offen
    v_add_u32 v14, 2, v13
    v_cmp_le_u32 vcc, s45, v14
    v_add_u32 v14, s44, v14
    v_lshl_add_u32 v14, v14, 6, v10
    v_cndmask_b32 v14, v45, v14, vcc
    buffer_load_ushort v114, v14, s[36:39], 0 offen
    s_mov_b32 s45, 0
L_SR_ISS_sp:
    ds_read_b32 v1, v12 offset:140
    s_add_u32 s45, s45, 1
    s_waitcnt lgkmcnt(0)
    v_readfirstlane_b32 s44, v1
    s_cmp_ge_u32 s45, 262144
    s_cbranch_scc1 L_SR_ISS_ok
    s_cmp_ge_u32 s44, 1
    s_cbranch_scc0 L_SR_ISS_sp
L_SR_ISS_ok:
    s_mov_b32 s48, 0
    v_lshlrev_b32 v11, 4, v0
L_SR_RETRY:
    s_lshl_b32 s44, s4, 14
    s_add_u32 s44, s44, 1310720
    s_lshl_b32 s45, s5, 13
    s_add_u32 s45, s45, 1572864
    buffer_load_dwordx4 v[16:19], v11, s[28:31], s44 offen sc1
    buffer_load_dwordx4 v[20:23], v11, s[28:31], s44 offen offset:1024 sc1
    buffer_load_dwordx4 v[80:83], v11, s[28:31], s45 offen sc1
    s_add_u32 s44, s44, 2048
    s_add_u32 s45, s45, 1024
    buffer_load_dwordx4 v[24:27], v11, s[28:31], s44 offen sc1
    buffer_load_dwordx4 v[28:31], v11, s[28:31], s44 offen offset:1024 sc1
    buffer_load_dwordx4 v[84:87], v11, s[28:31], s45 offen sc1
    s_add_u32 s44, s44, 2048
    s_add_u32 s45, s45, 1024
    buffer_load_dwordx4 v[32:35], v11, s[28:31], s44 offen sc1
    buffer_load_dwordx4 v[36:39], v11, s[28:31], s44 offen offset:1024 sc1
    buffer_load_dwordx4 v[88:91], v11, s[28:31], s45 offen sc1
    s_add_u32 s44, s44, 2048
    s_add_u32 s45, s45, 1024
    buffer_load_dwordx4 v[40:43], v11, s[28:31], s44 offen sc1
    buffer_load_dwordx4 v[44:47], v11, s[28:31], s44 offen offset:1024 sc1
    buffer_load_dwordx4 v[92:95], v11, s[28:31], s45 offen sc1
    s_add_u32 s44, s44, 2048
    s_add_u32 s45, s45, 1024
    buffer_load_dwordx4 v[48:51], v11, s[28:31], s44 offen sc1
    buffer_load_dwordx4 v[52:55], v11, s[28:31], s44 offen offset:1024 sc1
    buffer_load_dwordx4 v[96:99], v11, s[28:31], s45 offen sc1
    s_add_u32 s44, s44, 2048
    s_add_u32 s45, s45, 1024
    buffer_load_dwordx4 v[56:59], v11, s[28:31], s44 offen sc1
    buffer_load_dwordx4 v[60:63], v11, s[28:31], s44 offen offset:1024 sc1
    buffer_load_dwordx4 v[100:103], v11, s[28:31], s45 offen sc1
    s_add_u32 s44, s44, 2048
    s_add_u32 s45, s45, 1024
    buffer_load_dwordx4 v[64:67], v11, s[28:31], s44 offen sc1
    buffer_load_dwordx4 v[68:71], v11, s[28:31], s44 offen offset:1024 sc1
    buffer_load_dwordx4 v[104:107], v11, s[28:31], s45 offen sc1
    s_add_u32 s44, s44, 2048
    s_add_u32 s45, s45, 1024
    buffer_load_dwordx4 v[72:75], v11, s[28:31], s44 offen sc1
    buffer_load_dwordx4 v[76:79], v11, s[28:31], s44 offen offset:1024 sc1
    buffer_load_dwordx4 v[108:111], v11, s[28:31], s45 offen sc1
    s_add_u32 s44, s44, 2048
    s_add_u32 s45, s45, 1024
    s_mov_b64 exec, 1
    ds_add_u32 v12, v9 offset:136
    s_mov_b64 exec, -1
    s_waitcnt vmcnt(0)
    v_xor_b32 v10, s42, v18
    v_xor_b32 v13, s43, v19
    v_or_b32 v10, v10, v13
    v_xor_b32 v13, s42, v22
    v_or_b32 v10, v10, v13
    v_xor_b32 v13, s43, v23
    v_or_b32 v10, v10, v13
    v_xor_b32 v13, s42, v83
    v_or_b32 v10, v10, v13
    v_xor_b32 v13, s42, v26
    v_or_b32 v10, v10, v13
    v_xor_b32 v13, s43, v27
    v_or_b32 v10, v10, v13
    v_xor_b32 v13, s42, v30
    v_or_b32 v10, v10, v13
    v_xor_b32 v13, s43, v31
    v_or_b32 v10, v10, v13
    v_xor_b32 v13, s42, v87
    v_or_b32 v10, v10, v13
    v_xor_b32 v13, s42, v34
    v_or_b32 v10, v10, v13
    v_xor_b32 v13, s43, v35
    v_or_b32 v10, v10, v13
    v_xor_b32 v13, s42, v38
    v_or_b32 v10, v10, v13
    v_xor_b32 v13, s43, v39
    v_or_b32 v10, v10, v13
    v_xor_b32 v13, s42, v91
    v_or_b32 v10, v10, v13
    v_xor_b32 v13, s42, v42
    v_or_b32 v10, v10, v13
    v_xor_b32 v13, s43, v43
    v_or_b32 v10, v10, v13
    v_xor_b32 v13, s42, v46
    v_or_b32 v10, v10, v13
    v_xor_b32 v13, s43, v47
    v_or_b32 v10, v10, v13
    v_xor_b32 v13, s42, v95
    v_or_b32 v10, v10, v13
    v_xor_b32 v13, s42, v50
    v_or_b32 v10, v10, v13
    v_xor_b32 v13, s43, v51
    v_or_b32 v10, v10, v13
    v_xor_b32 v13, s42, v54
    v_or_b32 v10, v10, v13
    v_xor_b32 v13, s43, v55
    v_or_b32 v10, v10, v13
    v_xor_b32 v13, s42, v99
    v_or_b32 v10, v10, v13
    v_xor_b32 v13, s42, v58
    v_or_b32 v10, v10, v13
    v_xor_b32 v13, s43, v59
    v_or_b32 v10, v10, v13
    v_xor_b32 v13, s42, v62
    v_or_b32 v10, v10, v13
    v_xor_b32 v13, s43, v63
    v_or_b32 v10, v10, v13
    v_xor_b32 v13, s42, v103
    v_or_b32 v10, v10, v13
    v_xor_b32 v13, s42, v66
    v_or_b32 v10, v10, v13
    v_xor_b32 v13, s43, v67
    v_or_b32 v10, v10, v13
    v_xor_b32 v13, s42, v70
    v_or_b32 v10, v10, v13
    v_xor_b32 v13, s43, v71
    v_or_b32 v10, v10, v13
    v_xor_b32 v13, s42, v107
    v_or_b32 v10, v10, v13
    v_xor_b32 v13, s42, v74
    v_or_b32 v10, v10, v13
    v_xor_b32 v13, s43, v75
    v_or_b32 v10, v10, v13
    v_xor_b32 v13, s42, v78
    v_or_b32 v10, v10, v13
    v_xor_b32 v13, s43, v79
    v_or_b32 v10, v10, v13
    v_xor_b32 v13, s42, v111
    v_or_b32 v10, v10, v13
    v_cmp_ne_u32 vcc, 0, v10
    s_add_u32 s48, s48, 1
    s_nop 0
    s_cmp_eq_u64 vcc, 0
    s_cbranch_scc1 L_SR_OK
    s_cmp_ge_u32 s48, 8192
    s_cbranch_scc1 L_SR_OK
    s_sleep 2
    s_branch L_SR_RETRY
L_SR_OK:
    v_add_f32 v16, v16, v24
    v_add_f32 v17, v17, v25
    v_add_f32 v20, v20, v28
    v_add_f32 v21, v21, v29
    v_add_f32 v80, v80, v84
    v_add_f32 v81, v81, v85
    v_add_f32 v82, v82, v86
    v_add_f32 v16, v16, v32
    v_add_f32 v17, v17, v33
    v_add_f32 v20, v20, v36
    v_add_f32 v21, v21, v37
    v_add_f32 v80, v80, v88
    v_add_f32 v81, v81, v89
    v_add_f32 v82, v82, v90
    v_add_f32 v16, v16, v40
    v_add_f32 v17, v17, v41
    v_add_f32 v20, v20, v44
    v_add_f32 v21, v21, v45
    v_add_f32 v80, v80, v92
    v_add_f32 v81, v81, v93
    v_add_f32 v82, v82, v94
    v_add_f32 v16, v16, v48
    v_add_f32 v17, v17, v49
    v_add_f32 v20, v20, v52
    v_add_f32 v21, v21, v53
    v_add_f32 v80, v80, v96
    v_add_f32 v81, v81, v97
    v_add_f32 v82, v82, v98
    v_add_f32 v16, v16, v56
    v_add_f32 v17, v17, v57
    v_add_f32 v20, v20, v60
    v_add_f32 v21, v21, v61
    v_add_f32 v80, v80, v100
    v_add_f32 v81, v81, v101
    v_add_f32 v82, v82, v102
    v_add_f32 v16, v16, v64
    v_add_f32 v17, v17, v65
    v_add_f32 v20, v20, v68
    v_add_f32 v21, v21, v69
    v_add_f32 v80, v80, v104
    v_add_f32 v81, v81, v105
    v_add_f32 v82, v82, v106
    v_add_f32 v16, v16, v72
    v_add_f32 v17, v17, v73
    v_add_f32 v20, v20, v76
    v_add_f32 v21, v21, v77
    v_add_f32 v80, v80, v108
    v_add_f32 v81, v81, v109
    v_add_f32 v82, v82, v110
    s_mov_b32 s44, 0x3b000000
    s_mov_b32 s45, 0x3727c5ac
    s_mov_b32 s46, 0xffff0000
    v_mul_f32 v40, s44, v16
    v_mul_f32 v13, s44, v17
    v_fma_f32 v13, -v40, v40, v13
    v_max_f32 v13, 0, v13
    v_add_f32 v13, s45, v13
    v_sqrt_f32 v32, v13
    v_rsq_f32 v33, v13
    v_sub_f32 v41, 0, v40
    v_cvt_pk_bf16_f32 v24, v41, v41
    v_and_b32 v42, s46, v24
    v_sub_f32 v42, v41, v42
    v_cvt_pk_bf16_f32 v25, v42, v32
    v_and_b32 v43, s46, v25
    v_sub_f32 v43, v32, v43
    v_mov_b32 v44, 0
    v_cvt_pk_bf16_f32 v26, v43, v44
    v_mov_b32 v27, 0
    v_mul_f32 v40, s44, v20
    v_mul_f32 v13, s44, v21
    v_fma_f32 v13, -v40, v40, v13
    v_max_f32 v13, 0, v13
    v_add_f32 v13, s45, v13
    v_sqrt_f32 v34, v13
    v_rsq_f32 v35, v13
    v_sub_f32 v41, 0, v40
    v_cvt_pk_bf16_f32 v28, v41, v41
    v_and_b32 v42, s46, v28
    v_sub_f32 v42, v41, v42
    v_cvt_pk_bf16_f32 v29, v42, v34
    v_and_b32 v43, s46, v29
    v_sub_f32 v43, v34, v43
    v_mov_b32 v44, 0
    v_cvt_pk_bf16_f32 v30, v43, v44
    v_mov_b32 v31, 0
    v_cvt_pk_bf16_f32 v40, v80, v80
    v_and_b32 v41, s46, v40
    v_sub_f32 v42, v80, v41
    v_cvt_pk_bf16_f32 v48, v41, v42
    v_lshrrev_b32 v43, 16, v41
    v_lshl_or_b32 v49, v112, 16, v43
    v_mov_b32 v50, v112
    v_mov_b32 v51, 0
    v_cvt_pk_bf16_f32 v40, v81, v81
    v_and_b32 v41, s46, v40
    v_sub_f32 v42, v81, v41
    v_cvt_pk_bf16_f32 v52, v41, v42
    v_lshrrev_b32 v43, 16, v41
    v_lshl_or_b32 v53, v113, 16, v43
    v_mov_b32 v54, v113
    v_mov_b32 v55, 0
    v_cvt_pk_bf16_f32 v40, v82, v82
    v_and_b32 v41, s46, v40
    v_sub_f32 v42, v82, v41
    v_cvt_pk_bf16_f32 v56, v41, v42
    v_lshrrev_b32 v43, 16, v41
    v_lshl_or_b32 v57, v114, 16, v43
    v_mov_b32 v58, v114
    v_mov_b32 v59, 0
    v_lshlrev_b32 v10, 4, v0
    v_add_u32 v10, 123136, v10
    ds_write_b128 v10, v[24:27]
    ds_write_b128 v10, v[28:31] offset:1024
    v_lshlrev_b32 v10, 3, v0
    v_add_u32 v10, 125184, v10
    ds_write_b64 v10, v[32:33]
    ds_write_b64 v10, v[34:35] offset:512
    v_lshlrev_b32 v10, 2, v0
    v_add_u32 v10, 126208, v10
    ds_write_b32 v10, v33
    ds_write_b32 v10, v35 offset:256
    v_lshrrev_b32 v10, 5, v0
    v_mul_u32_u24 v10, 1536, v10
    v_and_b32 v11, 31, v0
    v_lshl_add_u32 v10, v11, 4, v10
    v_add_u32 v10, 126720, v10
    ds_write_b128 v10, v[48:51]
    ds_write_b128 v10, v[52:55] offset:512
    ds_write_b128 v10, v[56:59] offset:1024
    s_waitcnt lgkmcnt(0)
    s_mov_b64 exec, 1
    ds_add_u32 v12, v9 offset:132
    s_mov_b64 exec, -1
    s_branch L_H_B
L_H_COL:
    v_lshrrev_b32 v13, 5, v0
    v_bfe_u32 v14, v0, 2, 2
    v_lshl_add_u32 v10, v13, 3, v14
    v_lshlrev_b32 v10, 7, v10
    v_lshrrev_b32 v14, 1, v14
    v_lshl_add_u32 v10, v14, 6, v10
    v_bfe_u32 v14, v0, 4, 1
    v_lshl_add_u32 v10, v14, 5, v10
    v_and_b32 v14, 3, v0
    v_lshl_add_u32 v10, v14, 3, v10
    v_add_u32 v10, 16384, v10
    v_xor_b32 v11, 64, v10
    v_lshrrev_b32 v13, 5, v0
    v_bfe_u32 v14, v0, 2, 2
    v_lshl_add_u32 v13, v13, 3, v14
    v_lshlrev_b32 v13, 8, v13
    v_lshl_add_u32 v13, v14, 6, v13
    v_bfe_u32 v14, v0, 4, 1
    v_lshl_add_u32 v13, v14, 5, v13
    v_and_b32 v14, 3, v0
    v_lshl_add_u32 v13, v14, 3, v13
    v_add_u32 v13, 24576, v13
    ds_read_b64_tr_b16 v[16:17], v10 offset:0
    ds_read_b64_tr_b16 v[18:19], v10 offset:512
    ds_read_b64_tr_b16 v[20:21], v10 offset:2048
    ds_read_b64_tr_b16 v[22:23], v10 offset:2560
    ds_read_b64_tr_b16 v[24:25], v10 offset:4096
    ds_read_b64_tr_b16 v[26:27], v10 offset:4608
    ds_read_b64_tr_b16 v[28:29], v10 offset:6144
    ds_read_b64_tr_b16 v[30:31], v10 offset:6656
    s_waitcnt lgkmcnt(7)
    ds_read_b64_tr_b16 v[32:33], v11 offset:0
    ds_read_b64_tr_b16 v[34:35], v11 offset:512
    ds_read_b64_tr_b16 v[36:37], v11 offset:2048
    ds_read_b64_tr_b16 v[38:39], v11 offset:2560
    ds_read_b64_tr_b16 v[40:41], v11 offset:4096
    ds_read_b64_tr_b16 v[42:43], v11 offset:4608
    ds_read_b64_tr_b16 v[44:45], v11 offset:6144
    ds_read_b64_tr_b16 v[46:47], v11 offset:6656
    s_waitcnt lgkmcnt(7)
    s_cmp_eq_u32 s6, 0
    s_cbranch_scc0 L_SC_TB
    ds_read_b64_tr_b16 v[48:49], v10 offset:8192
    ds_read_b64_tr_b16 v[50:51], v10 offset:8704
    ds_read_b64_tr_b16 v[52:53], v10 offset:10240
    ds_read_b64_tr_b16 v[54:55], v10 offset:10752
    ds_read_b64_tr_b16 v[56:57], v10 offset:12288
    ds_read_b64_tr_b16 v[58:59], v10 offset:12800
    ds_read_b64_tr_b16 v[60:61], v10 offset:14336
    ds_read_b64_tr_b16 v[62:63], v10 offset:14848
    s_waitcnt lgkmcnt(7)
    ds_read_b64_tr_b16 v[64:65], v11 offset:8192
    ds_read_b64_tr_b16 v[66:67], v11 offset:8704
    ds_read_b64_tr_b16 v[68:69], v11 offset:10240
    ds_read_b64_tr_b16 v[70:71], v11 offset:10752
    ds_read_b64_tr_b16 v[72:73], v11 offset:12288
    ds_read_b64_tr_b16 v[74:75], v11 offset:12800
    ds_read_b64_tr_b16 v[76:77], v11 offset:14336
    ds_read_b64_tr_b16 v[78:79], v11 offset:14848
    s_waitcnt lgkmcnt(7)
    ds_read_b64_tr_b16 v[80:81], v10 offset:16384
    ds_read_b64_tr_b16 v[82:83], v10 offset:16896
    ds_read_b64_tr_b16 v[84:85], v10 offset:18432
    ds_read_b64_tr_b16 v[86:87], v10 offset:18944
    ds_read_b64_tr_b16 v[88:89], v10 offset:20480
    ds_read_b64_tr_b16 v[90:91], v10 offset:20992
    ds_read_b64_tr_b16 v[92:93], v10 offset:22528
    ds_read_b64_tr_b16 v[94:95], v10 offset:23040
    s_waitcnt lgkmcnt(7)
    ds_read_b64_tr_b16 v[96:97], v11 offset:16384
    ds_read_b64_tr_b16 v[98:99], v11 offset:16896
    ds_read_b64_tr_b16 v[100:101], v11 offset:18432
    ds_read_b64_tr_b16 v[102:103], v11 offset:18944
    ds_read_b64_tr_b16 v[104:105], v11 offset:20480
    ds_read_b64_tr_b16 v[106:107], v11 offset:20992
    ds_read_b64_tr_b16 v[108:109], v11 offset:22528
    ds_read_b64_tr_b16 v[110:111], v11 offset:23040
    s_waitcnt lgkmcnt(7)
    s_branch L_SC_TD
L_SC_TB:
    v_xor_b32 v14, 0, v13
    ds_read_b64_tr_b16 v[48:49], v14 offset:0
    ds_read_b64_tr_b16 v[50:51], v14 offset:1024
    ds_read_b64_tr_b16 v[52:53], v14 offset:4096
    ds_read_b64_tr_b16 v[54:55], v14 offset:5120
    ds_read_b64_tr_b16 v[56:57], v14 offset:8192
    ds_read_b64_tr_b16 v[58:59], v14 offset:9216
    ds_read_b64_tr_b16 v[60:61], v14 offset:12288
    ds_read_b64_tr_b16 v[62:63], v14 offset:13312
    s_waitcnt lgkmcnt(7)
    v_xor_b32 v14, 64, v13
    ds_read_b64_tr_b16 v[64:65], v14 offset:0
    ds_read_b64_tr_b16 v[66:67], v14 offset:1024
    ds_read_b64_tr_b16 v[68:69], v14 offset:4096
    ds_read_b64_tr_b16 v[70:71], v14 offset:5120
    ds_read_b64_tr_b16 v[72:73], v14 offset:8192
    ds_read_b64_tr_b16 v[74:75], v14 offset:9216
    ds_read_b64_tr_b16 v[76:77], v14 offset:12288
    ds_read_b64_tr_b16 v[78:79], v14 offset:13312
    s_waitcnt lgkmcnt(7)
    v_xor_b32 v14, 128, v13
    ds_read_b64_tr_b16 v[80:81], v14 offset:0
    ds_read_b64_tr_b16 v[82:83], v14 offset:1024
    ds_read_b64_tr_b16 v[84:85], v14 offset:4096
    ds_read_b64_tr_b16 v[86:87], v14 offset:5120
    ds_read_b64_tr_b16 v[88:89], v14 offset:8192
    ds_read_b64_tr_b16 v[90:91], v14 offset:9216
    ds_read_b64_tr_b16 v[92:93], v14 offset:12288
    ds_read_b64_tr_b16 v[94:95], v14 offset:13312
    s_waitcnt lgkmcnt(7)
    v_xor_b32 v14, 192, v13
    ds_read_b64_tr_b16 v[96:97], v14 offset:0
    ds_read_b64_tr_b16 v[98:99], v14 offset:1024
    ds_read_b64_tr_b16 v[100:101], v14 offset:4096
    ds_read_b64_tr_b16 v[102:103], v14 offset:5120
    ds_read_b64_tr_b16 v[104:105], v14 offset:8192
    ds_read_b64_tr_b16 v[106:107], v14 offset:9216
    ds_read_b64_tr_b16 v[108:109], v14 offset:12288
    ds_read_b64_tr_b16 v[110:111], v14 offset:13312
    s_waitcnt lgkmcnt(7)
L_SC_TD:
    s_waitcnt lgkmcnt(0)
    s_mov_b64 exec, 1
    ds_add_u32 v12, v9 offset:64
    s_mov_b64 exec, -1
    s_mov_b32 s46, 0xffff0000
    v_mov_b32 v112, 0
    v_mov_b32 v113, 0
    v_mov_b32 v114, 0
    v_mov_b32 v115, 0
    v_mov_b32 v116, 0
    v_mov_b32 v117, 0
    v_mov_b32 v118, 0
    v_mov_b32 v119, 0
    v_mov_b32 v120, 0
    v_mov_b32 v121, 0
    v_mov_b32 v122, 0
    v_mov_b32 v123, 0
    v_lshlrev_b32 v124, 16, v16
    v_and_b32 v125, s46, v16
    v_add_f32 v112, v112, v124
    v_add_f32 v113, v113, v125
    v_lshlrev_b32 v126, 16, v32
    v_and_b32 v127, s46, v32
    v_add_f32 v114, v114, v126
    v_add_f32 v115, v115, v127
    v_lshlrev_b32 v124, 16, v48
    v_and_b32 v125, s46, v48
    v_add_f32 v116, v116, v124
    v_add_f32 v117, v117, v125
    v_lshlrev_b32 v126, 16, v64
    v_and_b32 v127, s46, v64
    v_add_f32 v118, v118, v126
    v_add_f32 v119, v119, v127
    v_lshlrev_b32 v124, 16, v80
    v_and_b32 v125, s46, v80
    v_add_f32 v120, v120, v124
    v_add_f32 v121, v121, v125
    v_lshlrev_b32 v126, 16, v96
    v_and_b32 v127, s46, v96
    v_add_f32 v122, v122, v126
    v_add_f32 v123, v123, v127
    v_lshlrev_b32 v124, 16, v17
    v_and_b32 v125, s46, v17
    v_add_f32 v112, v112, v124
    v_add_f32 v113, v113, v125
    v_lshlrev_b32 v126, 16, v33
    v_and_b32 v127, s46, v33
    v_add_f32 v114, v114, v126
    v_add_f32 v115, v115, v127
    v_lshlrev_b32 v124, 16, v49
    v_and_b32 v125, s46, v49
    v_add_f32 v116, v116, v124
    v_add_f32 v117, v117, v125
    v_lshlrev_b32 v126, 16, v65
    v_and_b32 v127, s46, v65
    v_add_f32 v118, v118, v126
    v_add_f32 v119, v119, v127
    v_lshlrev_b32 v124, 16, v81
    v_and_b32 v125, s46, v81
    v_add_f32 v120, v120, v124
    v_add_f32 v121, v121, v125
    v_lshlrev_b32 v126, 16, v97
    v_and_b32 v127, s46, v97
    v_add_f32 v122, v122, v126
    v_add_f32 v123, v123, v127
    v_lshlrev_b32 v124, 16, v18
    v_and_b32 v125, s46, v18
    v_add_f32 v112, v112, v124
    v_add_f32 v113, v113, v125
    v_lshlrev_b32 v126, 16, v34
    v_and_b32 v127, s46, v34
    v_add_f32 v114, v114, v126
    v_add_f32 v115, v115, v127
    v_lshlrev_b32 v124, 16, v50
    v_and_b32 v125, s46, v50
    v_add_f32 v116, v116, v124
    v_add_f32 v117, v117, v125
    v_lshlrev_b32 v126, 16, v66
    v_and_b32 v127, s46, v66
    v_add_f32 v118, v118, v126
    v_add_f32 v119, v119, v127
    v_lshlrev_b32 v124, 16, v82
    v_and_b32 v125, s46, v82
    v_add_f32 v120, v120, v124
    v_add_f32 v121, v121, v125
    v_lshlrev_b32 v126, 16, v98
    v_and_b32 v127, s46, v98
    v_add_f32 v122, v122, v126
    v_add_f32 v123, v123, v127
    v_lshlrev_b32 v124, 16, v19
    v_and_b32 v125, s46, v19
    v_add_f32 v112, v112, v124
    v_add_f32 v113, v113, v125
    v_lshlrev_b32 v126, 16, v35
    v_and_b32 v127, s46, v35
    v_add_f32 v114, v114, v126
    v_add_f32 v115, v115, v127
    v_lshlrev_b32 v124, 16, v51
    v_and_b32 v125, s46, v51
    v_add_f32 v116, v116, v124
    v_add_f32 v117, v117, v125
    v_lshlrev_b32 v126, 16, v67
    v_and_b32 v127, s46, v67
    v_add_f32 v118, v118, v126
    v_add_f32 v119, v119, v127
    v_lshlrev_b32 v124, 16, v83
    v_and_b32 v125, s46, v83
    v_add_f32 v120, v120, v124
    v_add_f32 v121, v121, v125
    v_lshlrev_b32 v126, 16, v99
    v_and_b32 v127, s46, v99
    v_add_f32 v122, v122, v126
    v_add_f32 v123, v123, v127
    v_lshlrev_b32 v124, 16, v20
    v_and_b32 v125, s46, v20
    v_add_f32 v112, v112, v124
    v_add_f32 v113, v113, v125
    v_lshlrev_b32 v126, 16, v36
    v_and_b32 v127, s46, v36
    v_add_f32 v114, v114, v126
    v_add_f32 v115, v115, v127
    v_lshlrev_b32 v124, 16, v52
    v_and_b32 v125, s46, v52
    v_add_f32 v116, v116, v124
    v_add_f32 v117, v117, v125
    v_lshlrev_b32 v126, 16, v68
    v_and_b32 v127, s46, v68
    v_add_f32 v118, v118, v126
    v_add_f32 v119, v119, v127
    v_lshlrev_b32 v124, 16, v84
    v_and_b32 v125, s46, v84
    v_add_f32 v120, v120, v124
    v_add_f32 v121, v121, v125
    v_lshlrev_b32 v126, 16, v100
    v_and_b32 v127, s46, v100
    v_add_f32 v122, v122, v126
    v_add_f32 v123, v123, v127
    v_lshlrev_b32 v124, 16, v21
    v_and_b32 v125, s46, v21
    v_add_f32 v112, v112, v124
    v_add_f32 v113, v113, v125
    v_lshlrev_b32 v126, 16, v37
    v_and_b32 v127, s46, v37
    v_add_f32 v114, v114, v126
    v_add_f32 v115, v115, v127
    v_lshlrev_b32 v124, 16, v53
    v_and_b32 v125, s46, v53
    v_add_f32 v116, v116, v124
    v_add_f32 v117, v117, v125
    v_lshlrev_b32 v126, 16, v69
    v_and_b32 v127, s46, v69
    v_add_f32 v118, v118, v126
    v_add_f32 v119, v119, v127
    v_lshlrev_b32 v124, 16, v85
    v_and_b32 v125, s46, v85
    v_add_f32 v120, v120, v124
    v_add_f32 v121, v121, v125
    v_lshlrev_b32 v126, 16, v101
    v_and_b32 v127, s46, v101
    v_add_f32 v122, v122, v126
    v_add_f32 v123, v123, v127
    v_lshlrev_b32 v124, 16, v22
    v_and_b32 v125, s46, v22
    v_add_f32 v112, v112, v124
    v_add_f32 v113, v113, v125
    v_lshlrev_b32 v126, 16, v38
    v_and_b32 v127, s46, v38
    v_add_f32 v114, v114, v126
    v_add_f32 v115, v115, v127
    v_lshlrev_b32 v124, 16, v54
    v_and_b32 v125, s46, v54
    v_add_f32 v116, v116, v124
    v_add_f32 v117, v117, v125
    v_lshlrev_b32 v126, 16, v70
    v_and_b32 v127, s46, v70
    v_add_f32 v118, v118, v126
    v_add_f32 v119, v119, v127
    v_lshlrev_b32 v124, 16, v86
    v_and_b32 v125, s46, v86
    v_add_f32 v120, v120, v124
    v_add_f32 v121, v121, v125
    v_lshlrev_b32 v126, 16, v102
    v_and_b32 v127, s46, v102
    v_add_f32 v122, v122, v126
    v_add_f32 v123, v123, v127
    v_lshlrev_b32 v124, 16, v23
    v_and_b32 v125, s46, v23
    v_add_f32 v112, v112, v124
    v_add_f32 v113, v113, v125
    v_lshlrev_b32 v126, 16, v39
    v_and_b32 v127, s46, v39
    v_add_f32 v114, v114, v126
    v_add_f32 v115, v115, v127
    v_lshlrev_b32 v124, 16, v55
    v_and_b32 v125, s46, v55
    v_add_f32 v116, v116, v124
    v_add_f32 v117, v117, v125
    v_lshlrev_b32 v126, 16, v71
    v_and_b32 v127, s46, v71
    v_add_f32 v118, v118, v126
    v_add_f32 v119, v119, v127
    v_lshlrev_b32 v124, 16, v87
    v_and_b32 v125, s46, v87
    v_add_f32 v120, v120, v124
    v_add_f32 v121, v121, v125
    v_lshlrev_b32 v126, 16, v103
    v_and_b32 v127, s46, v103
    v_add_f32 v122, v122, v126
    v_add_f32 v123, v123, v127
    v_lshlrev_b32 v124, 16, v24
    v_and_b32 v125, s46, v24
    v_add_f32 v112, v112, v124
    v_add_f32 v113, v113, v125
    v_lshlrev_b32 v126, 16, v40
    v_and_b32 v127, s46, v40
    v_add_f32 v114, v114, v126
    v_add_f32 v115, v115, v127
    v_lshlrev_b32 v124, 16, v56
    v_and_b32 v125, s46, v56
    v_add_f32 v116, v116, v124
    v_add_f32 v117, v117, v125
    v_lshlrev_b32 v126, 16, v72
    v_and_b32 v127, s46, v72
    v_add_f32 v118, v118, v126
    v_add_f32 v119, v119, v127
    v_lshlrev_b32 v124, 16, v88
    v_and_b32 v125, s46, v88
    v_add_f32 v120, v120, v124
    v_add_f32 v121, v121, v125
    v_lshlrev_b32 v126, 16, v104
    v_and_b32 v127, s46, v104
    v_add_f32 v122, v122, v126
    v_add_f32 v123, v123, v127
    v_lshlrev_b32 v124, 16, v25
    v_and_b32 v125, s46, v25
    v_add_f32 v112, v112, v124
    v_add_f32 v113, v113, v125
    v_lshlrev_b32 v126, 16, v41
    v_and_b32 v127, s46, v41
    v_add_f32 v114, v114, v126
    v_add_f32 v115, v115, v127
    v_lshlrev_b32 v124, 16, v57
    v_and_b32 v125, s46, v57
    v_add_f32 v116, v116, v124
    v_add_f32 v117, v117, v125
    v_lshlrev_b32 v126, 16, v73
    v_and_b32 v127, s46, v73
    v_add_f32 v118, v118, v126
    v_add_f32 v119, v119, v127
    v_lshlrev_b32 v124, 16, v89
    v_and_b32 v125, s46, v89
    v_add_f32 v120, v120, v124
    v_add_f32 v121, v121, v125
    v_lshlrev_b32 v126, 16, v105
    v_and_b32 v127, s46, v105
    v_add_f32 v122, v122, v126
    v_add_f32 v123, v123, v127
    v_lshlrev_b32 v124, 16, v26
    v_and_b32 v125, s46, v26
    v_add_f32 v112, v112, v124
    v_add_f32 v113, v113, v125
    v_lshlrev_b32 v126, 16, v42
    v_and_b32 v127, s46, v42
    v_add_f32 v114, v114, v126
    v_add_f32 v115, v115, v127
    v_lshlrev_b32 v124, 16, v58
    v_and_b32 v125, s46, v58
    v_add_f32 v116, v116, v124
    v_add_f32 v117, v117, v125
    v_lshlrev_b32 v126, 16, v74
    v_and_b32 v127, s46, v74
    v_add_f32 v118, v118, v126
    v_add_f32 v119, v119, v127
    v_lshlrev_b32 v124, 16, v90
    v_and_b32 v125, s46, v90
    v_add_f32 v120, v120, v124
    v_add_f32 v121, v121, v125
    v_lshlrev_b32 v126, 16, v106
    v_and_b32 v127, s46, v106
    v_add_f32 v122, v122, v126
    v_add_f32 v123, v123, v127
    v_lshlrev_b32 v124, 16, v27
    v_and_b32 v125, s46, v27
    v_add_f32 v112, v112, v124
    v_add_f32 v113, v113, v125
    v_lshlrev_b32 v126, 16, v43
    v_and_b32 v127, s46, v43
    v_add_f32 v114, v114, v126
    v_add_f32 v115, v115, v127
    v_lshlrev_b32 v124, 16, v59
    v_and_b32 v125, s46, v59
    v_add_f32 v116, v116, v124
    v_add_f32 v117, v117, v125
    v_lshlrev_b32 v126, 16, v75
    v_and_b32 v127, s46, v75
    v_add_f32 v118, v118, v126
    v_add_f32 v119, v119, v127
    v_lshlrev_b32 v124, 16, v91
    v_and_b32 v125, s46, v91
    v_add_f32 v120, v120, v124
    v_add_f32 v121, v121, v125
    v_lshlrev_b32 v126, 16, v107
    v_and_b32 v127, s46, v107
    v_add_f32 v122, v122, v126
    v_add_f32 v123, v123, v127
    v_lshlrev_b32 v124, 16, v28
    v_and_b32 v125, s46, v28
    v_add_f32 v112, v112, v124
    v_add_f32 v113, v113, v125
    v_lshlrev_b32 v126, 16, v44
    v_and_b32 v127, s46, v44
    v_add_f32 v114, v114, v126
    v_add_f32 v115, v115, v127
    v_lshlrev_b32 v124, 16, v60
    v_and_b32 v125, s46, v60
    v_add_f32 v116, v116, v124
    v_add_f32 v117, v117, v125
    v_lshlrev_b32 v126, 16, v76
    v_and_b32 v127, s46, v76
    v_add_f32 v118, v118, v126
    v_add_f32 v119, v119, v127
    v_lshlrev_b32 v124, 16, v92
    v_and_b32 v125, s46, v92
    v_add_f32 v120, v120, v124
    v_add_f32 v121, v121, v125
    v_lshlrev_b32 v126, 16, v108
    v_and_b32 v127, s46, v108
    v_add_f32 v122, v122, v126
    v_add_f32 v123, v123, v127
    v_lshlrev_b32 v124, 16, v29
    v_and_b32 v125, s46, v29
    v_add_f32 v112, v112, v124
    v_add_f32 v113, v113, v125
    v_lshlrev_b32 v126, 16, v45
    v_and_b32 v127, s46, v45
    v_add_f32 v114, v114, v126
    v_add_f32 v115, v115, v127
    v_lshlrev_b32 v124, 16, v61
    v_and_b32 v125, s46, v61
    v_add_f32 v116, v116, v124
    v_add_f32 v117, v117, v125
    v_lshlrev_b32 v126, 16, v77
    v_and_b32 v127, s46, v77
    v_add_f32 v118, v118, v126
    v_add_f32 v119, v119, v127
    v_lshlrev_b32 v124, 16, v93
    v_and_b32 v125, s46, v93
    v_add_f32 v120, v120, v124
    v_add_f32 v121, v121, v125
    v_lshlrev_b32 v126, 16, v109
    v_and_b32 v127, s46, v109
    v_add_f32 v122, v122, v126
    v_add_f32 v123, v123, v127
    v_lshlrev_b32 v124, 16, v30
    v_and_b32 v125, s46, v30
    v_add_f32 v112, v112, v124
    v_add_f32 v113, v113, v125
    v_lshlrev_b32 v126, 16, v46
    v_and_b32 v127, s46, v46
    v_add_f32 v114, v114, v126
    v_add_f32 v115, v115, v127
    v_lshlrev_b32 v124, 16, v62
    v_and_b32 v125, s46, v62
    v_add_f32 v116, v116, v124
    v_add_f32 v117, v117, v125
    v_lshlrev_b32 v126, 16, v78
    v_and_b32 v127, s46, v78
    v_add_f32 v118, v118, v126
    v_add_f32 v119, v119, v127
    v_lshlrev_b32 v124, 16, v94
    v_and_b32 v125, s46, v94
    v_add_f32 v120, v120, v124
    v_add_f32 v121, v121, v125
    v_lshlrev_b32 v126, 16, v110
    v_and_b32 v127, s46, v110
    v_add_f32 v122, v122, v126
    v_add_f32 v123, v123, v127
    v_lshlrev_b32 v124, 16, v31
    v_and_b32 v125, s46, v31
    v_add_f32 v112, v112, v124
    v_add_f32 v113, v113, v125
    v_lshlrev_b32 v126, 16, v47
    v_and_b32 v127, s46, v47
    v_add_f32 v114, v114, v126
    v_add_f32 v115, v115, v127
    v_lshlrev_b32 v124, 16, v63
    v_and_b32 v125, s46, v63
    v_add_f32 v116, v116, v124
    v_add_f32 v117, v117, v125
    v_lshlrev_b32 v126, 16, v79
    v_and_b32 v127, s46, v79
    v_add_f32 v118, v118, v126
    v_add_f32 v119, v119, v127
    v_lshlrev_b32 v124, 16, v95
    v_and_b32 v125, s46, v95
    v_add_f32 v120, v120, v124
    v_add_f32 v121, v121, v125
    v_lshlrev_b32 v126, 16, v111
    v_and_b32 v127, s46, v111
    v_add_f32 v122, v122, v126
    v_add_f32 v123, v123, v127
    v_add_f32 v112, v112, v113
    v_mov_b32 v1, v112
    s_nop 1
    v_permlane32_swap_b32 v112, v1
    v_add_f32 v112, v112, v1
    v_add_f32 v114, v114, v115
    v_mov_b32 v1, v114
    s_nop 1
    v_permlane32_swap_b32 v114, v1
    v_add_f32 v114, v114, v1
    v_add_f32 v116, v116, v117
    v_mov_b32 v1, v116
    s_nop 1
    v_permlane32_swap_b32 v116, v1
    v_add_f32 v116, v116, v1
    v_add_f32 v118, v118, v119
    v_mov_b32 v1, v118
    s_nop 1
    v_permlane32_swap_b32 v118, v1
    v_add_f32 v118, v118, v1
    v_add_f32 v120, v120, v121
    v_mov_b32 v1, v120
    s_nop 1
    v_permlane32_swap_b32 v120, v1
    v_add_f32 v120, v120, v1
    v_add_f32 v122, v122, v123
    v_mov_b32 v1, v122
    s_nop 1
    v_permlane32_swap_b32 v122, v1
    v_add_f32 v122, v122, v1
    v_cmp_gt_u32 vcc, 32, v0
    s_nop 1
    v_cndmask_b32 v16, v118, v112, vcc
    v_cndmask_b32 v17, v120, v114, vcc
    v_cndmask_b32 v18, v122, v116, vcc
    v_mov_b32 v19, s42
    s_cmp_lt_u32 s4, 8
    s_cbranch_scc0 L_SC_NOPUB
    s_lshl_b32 s44, s5, 3
    s_add_u32 s44, s44, s7
    s_lshl_b32 s44, s44, 10
    s_add_u32 s44, s44, 1572864
    v_lshlrev_b32 v11, 4, v0
    buffer_store_dwordx4 v[16:19], v11, s[28:31], s44 offen sc1
L_SC_NOPUB:
    s_mov_b32 s45, 0
L_H_ISS7_sp:
    ds_read_b32 v1, v12 offset:136
    s_add_u32 s45, s45, 1
    s_waitcnt lgkmcnt(0)
    v_readfirstlane_b32 s44, v1
    s_cmp_ge_u32 s45, 262144
    s_cbranch_scc1 L_H_ISS7_ok
    s_cmp_ge_u32 s44, 1
    s_cbranch_scc0 L_H_ISS7_sp
L_H_ISS7_ok:
L_H_B:
    s_mov_b32 s20, s76
    s_and_b32 s21, s77, 0xffff
    s_mov_b32 s22, 1409024
    s_mov_b32 s23, 0x20000
    s_mov_b32 s24, s68
    s_and_b32 s25, s69, 0xffff
    s_mov_b32 s26, 524288
    s_mov_b32 s27, 0x20000
    s_mov_b32 s8, s64
    s_and_b32 s9, s65, 0xffff
    s_mov_b32 s10, 2097152
    s_mov_b32 s11, 0x20000
    s_mov_b32 s32, s80
    s_and_b32 s33, s81, 0xffff
    s_mov_b32 s34, 2097152
    s_mov_b32 s35, 0x20000
    s_mov_b32 s36, s78
    s_and_b32 s37, s79, 0xffff
    s_mov_b32 s38, 1024
    s_mov_b32 s39, 0x20000
    s_and_b32 s50, s49, 1
    s_lshr_b32 s51, s49, 1
    v_lshrrev_b32 v10, 3, v0
    v_and_b32 v11, 7, v0
    v_bfe_u32 v13, v0, 4, 1
    v_lshlrev_b32 v13, 2, v13
    v_xor_b32 v14, v11, v13
    v_lshlrev_b32 v14, 4, v14
    v_lshl_add_u32 v3, v10, 10, v14
    s_lshl_b32 s44, s51, 10
    v_lshlrev_b32 v2, 4, v0
    v_add_u32 v2, s44, v2
    v_xor_b32 v15, 0x400, v2
    v_mov_b32 v12, 122880
    v_lshrrev_b32 v10, 5, v0
    v_bfe_u32 v11, v0, 2, 2
    v_lshl_add_u32 v13, v10, 2, v11
    v_lshlrev_b32 v13, 7, v13
    v_lshrrev_b32 v14, 1, v11
    v_xor_b32 v14, s50, v14
    v_lshl_add_u32 v13, v14, 6, v13
    v_bfe_u32 v14, v0, 4, 1
    v_lshl_add_u32 v13, v14, 5, v13
    v_and_b32 v14, 3, v0
    v_lshl_add_u32 v13, v14, 3, v13
    s_lshl_b32 s44, s49, 13
    s_add_u32 s52, s44, 131072
    s_mul_i32 s44, s49, 10240
    s_add_u32 s53, s44, 81920
    s_mov_b32 s54, s44
    s_add_u32 s55, s44, 40960
    v_add_u32 v4, s52, v13
    v_xor_b32 v5, 64, v4
    v_add_u32 v6, s53, v13
    v_xor_b32 v7, 64, v6
    v_add_u32 v8, s54, v13
    v_xor_b32 v9, 64, v8
    v_add_u32 v10, s55, v13
    v_xor_b32 v11, 64, v10
    s_mul_i32 s56, s49, 360448
    s_lshl_b32 s44, s41, 7
    s_add_u32 s56, s56, s44
    s_lshl_b32 s57, s49, 17
    s_add_u32 s57, s57, s44
    s_and_b32 s44, s40, 3
    s_lshl_b32 s44, s44, 1
    s_add_u32 s44, s44, s41
    s_and_b32 s82, s44, 7
    s_mul_i32 s83, s82, 22
    s_lshr_b32 s83, s83, 3
    s_mov_b32 s61, s83
    s_mov_b32 s62, s82
    s_lshl_b32 s44, s61, 14
    s_add_u32 s44, s44, s56
    s_add_u32 m0, s52, 0
    s_add_u32 s45, s44, 8192
    buffer_load_dwordx4 v3, s[20:23], s44 offen lds
    s_add_u32 m0, s52, 1024
    s_add_u32 s61, s61, 1
    s_cmp_eq_u32 s61, 22
    s_cselect_b32 s61, 0, s61
    buffer_load_dwordx4 v3, s[20:23], s45 offen lds
    s_lshl_b32 s44, s61, 14
    s_add_u32 s44, s44, s56
    s_add_u32 m0, s52, 2048
    s_add_u32 s45, s44, 8192
    buffer_load_dwordx4 v3, s[20:23], s44 offen lds
    s_add_u32 m0, s52, 3072
    s_add_u32 s61, s61, 1
    s_cmp_eq_u32 s61, 22
    s_cselect_b32 s61, 0, s61
    buffer_load_dwordx4 v3, s[20:23], s45 offen lds
    s_lshl_b32 s44, s61, 14
    s_add_u32 s44, s44, s56
    s_add_u32 m0, s52, 4096
    s_add_u32 s45, s44, 8192
    buffer_load_dwordx4 v3, s[20:23], s44 offen lds
    s_add_u32 m0, s52, 5120
    s_add_u32 s61, s61, 1
    s_cmp_eq_u32 s61, 22
    s_cselect_b32 s61, 0, s61
    buffer_load_dwordx4 v3, s[20:23], s45 offen lds
    s_lshl_b32 s44, s61, 14
    s_add_u32 s44, s44, s56
    s_add_u32 m0, s52, 6144
    s_add_u32 s45, s44, 8192
    buffer_load_dwordx4 v3, s[20:23], s44 offen lds
    s_add_u32 m0, s52, 7168
    s_add_u32 s61, s61, 1
    s_cmp_eq_u32 s61, 22
    s_cselect_b32 s61, 0, s61
    buffer_load_dwordx4 v3, s[20:23], s45 offen lds
    s_mov_b32 s45, 0
L_P2_W5_sp:
    ds_read_b32 v1, v12 offset:84
    s_add_u32 s45, s45, 1
    s_waitcnt lgkmcnt(0)
    v_readfirstlane_b32 s44, v1
    s_cmp_ge_u32 s45, 262144
    s_cbranch_scc1 L_P2_W5_ok
    s_cmp_ge_u32 s44, 4
    s_cbranch_scc0 L_P2_W5_sp
L_P2_W5_ok:
    s_lshl_b32 s44, s61, 14
    s_add_u32 s44, s44, s56
    s_add_u32 m0, s53, 0
    s_add_u32 s45, s44, 8192
    buffer_load_dwordx4 v3, s[20:23], s44 offen lds
    s_add_u32 m0, s53, 1024
    s_add_u32 s61, s61, 1
    s_cmp_eq_u32 s61, 22
    s_cselect_b32 s61, 0, s61
    buffer_load_dwordx4 v3, s[20:23], s45 offen lds
    s_lshl_b32 s44, s61, 14
    s_add_u32 s44, s44, s56
    s_add_u32 m0, s53, 2048
    s_add_u32 s45, s44, 8192
    buffer_load_dwordx4 v3, s[20:23], s44 offen lds
    s_add_u32 m0, s53, 3072
    s_add_u32 s61, s61, 1
    s_cmp_eq_u32 s61, 22
    s_cselect_b32 s61, 0, s61
    buffer_load_dwordx4 v3, s[20:23], s45 offen lds
    s_lshl_b32 s44, s61, 14
    s_add_u32 s44, s44, s56
    s_add_u32 m0, s53, 4096
    s_add_u32 s45, s44, 8192
    buffer_load_dwordx4 v3, s[20:23], s44 offen lds
    s_add_u32 m0, s53, 5120
    s_add_u32 s61, s61, 1
    s_cmp_eq_u32 s61, 22
    s_cselect_b32 s61, 0, s61
    buffer_load_dwordx4 v3, s[20:23], s45 offen lds
    s_lshl_b32 s44, s61, 14
    s_add_u32 s44, s44, s56
    s_add_u32 m0, s53, 6144
    s_add_u32 s45, s44, 8192
    buffer_load_dwordx4 v3, s[20:23], s44 offen lds
    s_add_u32 m0, s53, 7168
    s_add_u32 s61, s61, 1
    s_cmp_eq_u32 s61, 22
    s_cselect_b32 s61, 0, s61
    buffer_load_dwordx4 v3, s[20:23], s45 offen lds
    s_lshl_b32 s44, s61, 14
    s_add_u32 s44, s44, s56
    s_add_u32 m0, s53, 8192
    s_add_u32 s45, s44, 8192
    buffer_load_dwordx4 v3, s[20:23], s44 offen lds
    s_add_u32 m0, s53, 9216
    s_add_u32 s61, s61, 1
    s_cmp_eq_u32 s61, 22
    s_cselect_b32 s61, 0, s61
    buffer_load_dwordx4 v3, s[20:23], s45 offen lds
    s_waitcnt vmcnt(10)
    ds_read_b64_tr_b16 v[64:65], v4 offset:0
    ds_read_b64_tr_b16 v[66:67], v4 offset:1024
    ds_read_b64_tr_b16 v[68:69], v5 offset:0
    ds_read_b64_tr_b16 v[70:71], v5 offset:1024
    ds_read_b64_tr_b16 v[72:73], v4 offset:2048
    ds_read_b64_tr_b16 v[74:75], v4 offset:3072
    ds_read_b64_tr_b16 v[76:77], v5 offset:2048
    ds_read_b64_tr_b16 v[78:79], v5 offset:3072
    ds_read_b64_tr_b16 v[80:81], v4 offset:4096
    ds_read_b64_tr_b16 v[82:83], v4 offset:5120
    ds_read_b64_tr_b16 v[84:85], v5 offset:4096
    ds_read_b64_tr_b16 v[86:87], v5 offset:5120
    s_waitcnt lgkmcnt(4)
    ds_read_b64_tr_b16 v[88:89], v4 offset:6144
    ds_read_b64_tr_b16 v[90:91], v4 offset:7168
    ds_read_b64_tr_b16 v[92:93], v5 offset:6144
    ds_read_b64_tr_b16 v[94:95], v5 offset:7168
    s_waitcnt lgkmcnt(0)
    s_lshl_b32 s44, s61, 14
    s_add_u32 s44, s44, s56
    s_add_u32 m0, s52, 0
    s_add_u32 s45, s44, 8192
    buffer_load_dwordx4 v3, s[20:23], s44 offen lds
    s_add_u32 m0, s52, 1024
    s_add_u32 s61, s61, 1
    s_cmp_eq_u32 s61, 22
    s_cselect_b32 s61, 0, s61
    buffer_load_dwordx4 v3, s[20:23], s45 offen lds
    s_lshl_b32 s44, s61, 14
    s_add_u32 s44, s44, s56
    s_add_u32 m0, s52, 2048
    s_add_u32 s45, s44, 8192
    buffer_load_dwordx4 v3, s[20:23], s44 offen lds
    s_add_u32 m0, s52, 3072
    s_add_u32 s61, s61, 1
    s_cmp_eq_u32 s61, 22
    s_cselect_b32 s61, 0, s61
    buffer_load_dwordx4 v3, s[20:23], s45 offen lds
    s_lshl_b32 s44, s61, 14
    s_add_u32 s44, s44, s56
    s_add_u32 m0, s52, 4096
    s_add_u32 s45, s44, 8192
    buffer_load_dwordx4 v3, s[20:23], s44 offen lds
    s_add_u32 m0, s52, 5120
    s_add_u32 s61, s61, 1
    s_cmp_eq_u32 s61, 22
    s_cselect_b32 s61, 0, s61
    buffer_load_dwordx4 v3, s[20:23], s45 offen lds
    s_lshl_b32 s44, s61, 14
    s_add_u32 s44, s44, s56
    s_add_u32 m0, s52, 6144
    s_add_u32 s45, s44, 8192
    buffer_load_dwordx4 v3, s[20:23], s44 offen lds
    s_add_u32 m0, s52, 7168
    s_add_u32 s61, s61, 1
    s_cmp_eq_u32 s61, 22
    s_cselect_b32 s61, 0, s61
    buffer_load_dwordx4 v3, s[20:23], s45 offen lds
    s_waitcnt vmcnt(8)
    ds_read_b64_tr_b16 v[96:97], v6 offset:0
    ds_read_b64_tr_b16 v[98:99], v6 offset:1024
    ds_read_b64_tr_b16 v[100:101], v7 offset:0
    ds_read_b64_tr_b16 v[102:103], v7 offset:1024
    ds_read_b64_tr_b16 v[104:105], v6 offset:2048
    ds_read_b64_tr_b16 v[106:107], v6 offset:3072
    ds_read_b64_tr_b16 v[108:109], v7 offset:2048
    ds_read_b64_tr_b16 v[110:111], v7 offset:3072
    ds_read_b64_tr_b16 v[112:113], v6 offset:4096
    ds_read_b64_tr_b16 v[114:115], v6 offset:5120
    ds_read_b64_tr_b16 v[116:117], v7 offset:4096
    ds_read_b64_tr_b16 v[118:119], v7 offset:5120
    s_waitcnt lgkmcnt(4)
    ds_read_b64_tr_b16 v[120:121], v6 offset:6144
    ds_read_b64_tr_b16 v[122:123], v6 offset:7168
    ds_read_b64_tr_b16 v[124:125], v7 offset:6144
    ds_read_b64_tr_b16 v[126:127], v7 offset:7168
    ds_read_b64_tr_b16 v[128:129], v6 offset:8192
    ds_read_b64_tr_b16 v[130:131], v6 offset:9216
    ds_read_b64_tr_b16 v[132:133], v7 offset:8192
    ds_read_b64_tr_b16 v[134:135], v7 offset:9216
    s_waitcnt lgkmcnt(4)
    s_waitcnt lgkmcnt(0)
    s_waitcnt vmcnt(2)
    ds_read_b64_tr_b16 v[136:137], v4 offset:0
    ds_read_b64_tr_b16 v[138:139], v4 offset:1024
    ds_read_b64_tr_b16 v[140:141], v5 offset:0
    ds_read_b64_tr_b16 v[142:143], v5 offset:1024
    ds_read_b64_tr_b16 v[144:145], v4 offset:2048
    ds_read_b64_tr_b16 v[146:147], v4 offset:3072
    ds_read_b64_tr_b16 v[148:149], v5 offset:2048
    ds_read_b64_tr_b16 v[150:151], v5 offset:3072
    ds_read_b64_tr_b16 v[152:153], v4 offset:4096
    ds_read_b64_tr_b16 v[154:155], v4 offset:5120
    ds_read_b64_tr_b16 v[156:157], v5 offset:4096
    ds_read_b64_tr_b16 v[158:159], v5 offset:5120
    s_waitcnt lgkmcnt(4)
    s_waitcnt lgkmcnt(0)
    s_mov_b32 s45, 0
L_P2_WE_sp:
    ds_read_b32 v1, v12 offset:144
    s_add_u32 s45, s45, 1
    s_waitcnt lgkmcnt(0)
    v_readfirstlane_b32 s44, v1
    s_cmp_ge_u32 s45, 262144
    s_cbranch_scc1 L_P2_WE_ok
    s_cmp_ge_u32 s44, 4
    s_cbranch_scc0 L_P2_WE_sp
L_P2_WE_ok:
    s_lshl_b32 s44, s61, 14
    s_add_u32 s44, s44, s56
    s_add_u32 m0, s53, 0
    s_add_u32 s45, s44, 8192
    buffer_load_dwordx4 v3, s[20:23], s44 offen lds
    s_add_u32 m0, s53, 1024
    s_add_u32 s61, s61, 1
    s_cmp_eq_u32 s61, 22
    s_cselect_b32 s61, 0, s61
    buffer_load_dwordx4 v3, s[20:23], s45 offen lds
    s_lshl_b32 s44, s61, 14
    s_add_u32 s44, s44, s56
    s_add_u32 m0, s53, 2048
    s_add_u32 s45, s44, 8192
    buffer_load_dwordx4 v3, s[20:23], s44 offen lds
    s_add_u32 m0, s53, 3072
    s_add_u32 s61, s61, 1
    s_cmp_eq_u32 s61, 22
    s_cselect_b32 s61, 0, s61
    buffer_load_dwordx4 v3, s[20:23], s45 offen lds
    s_lshl_b32 s44, s61, 14
    s_add_u32 s44, s44, s56
    s_add_u32 m0, s53, 4096
    s_add_u32 s45, s44, 8192
    buffer_load_dwordx4 v3, s[20:23], s44 offen lds
    s_add_u32 m0, s53, 5120
    s_add_u32 s61, s61, 1
    s_cmp_eq_u32 s61, 22
    s_cselect_b32 s61, 0, s61
    buffer_load_dwordx4 v3, s[20:23], s45 offen lds
    s_lshl_b32 s44, s61, 14
    s_add_u32 s44, s44, s56
    s_add_u32 m0, s53, 6144
    s_add_u32 s45, s44, 8192
    buffer_load_dwordx4 v3, s[20:23], s44 offen lds
    s_add_u32 m0, s53, 7168
    s_add_u32 s61, s61, 1
    s_cmp_eq_u32 s61, 22
    s_cselect_b32 s61, 0, s61
    buffer_load_dwordx4 v3, s[20:23], s45 offen lds
    s_lshl_b32 s44, s61, 14
    s_add_u32 s44, s44, s56
    s_add_u32 m0, s53, 8192
    s_add_u32 s45, s44, 8192
    buffer_load_dwordx4 v3, s[20:23], s44 offen lds
    s_add_u32 m0, s53, 9216
    s_add_u32 s61, s61, 1
    s_cmp_eq_u32 s61, 22
    s_cselect_b32 s61, 0, s61
    buffer_load_dwordx4 v3, s[20:23], s45 offen lds
    s_lshl_b32 s44, s61, 14
    s_add_u32 s44, s44, s56
    s_add_u32 m0, s54, 0
    s_add_u32 s45, s44, 8192
    buffer_load_dwordx4 v3, s[20:23], s44 offen lds
    s_add_u32 m0, s54, 1024
    s_add_u32 s61, s61, 1
    s_cmp_eq_u32 s61, 22
    s_cselect_b32 s61, 0, s61
    buffer_load_dwordx4 v3, s[20:23], s45 offen lds
    s_lshl_b32 s44, s61, 14
    s_add_u32 s44, s44, s56
    s_add_u32 m0, s54, 2048
    s_add_u32 s45, s44, 8192
    buffer_load_dwordx4 v3, s[20:23], s44 offen lds
    s_add_u32 m0, s54, 3072
    s_add_u32 s61, s61, 1
    s_cmp_eq_u32 s61, 22
    s_cselect_b32 s61, 0, s61
    buffer_load_dwordx4 v3, s[20:23], s45 offen lds
    s_lshl_b32 s44, s61, 14
    s_add_u32 s44, s44, s56
    s_add_u32 m0, s54, 4096
    s_add_u32 s45, s44, 8192
    buffer_load_dwordx4 v3, s[20:23], s44 offen lds
    s_add_u32 m0, s54, 5120
    s_add_u32 s61, s61, 1
    s_cmp_eq_u32 s61, 22
    s_cselect_b32 s61, 0, s61
    buffer_load_dwordx4 v3, s[20:23], s45 offen lds
    s_lshl_b32 s44, s61, 14
    s_add_u32 s44, s44, s56
    s_add_u32 m0, s54, 6144
    s_add_u32 s45, s44, 8192
    buffer_load_dwordx4 v3, s[20:23], s44 offen lds
    s_add_u32 m0, s54, 7168
    s_add_u32 s61, s61, 1
    s_cmp_eq_u32 s61, 22
    s_cselect_b32 s61, 0, s61
    buffer_load_dwordx4 v3, s[20:23], s45 offen lds
    s_lshl_b32 s44, s62, 14
    s_add_u32 s44, s44, s57
    s_add_u32 m0, s54, 8192
    s_add_u32 s45, s44, 8192
    buffer_load_dwordx4 v3, s[24:27], s44 offen lds
    s_add_u32 m0, s54, 9216
    s_add_u32 s62, s62, 1
    s_cmp_eq_u32 s62, 8
    s_cselect_b32 s62, 0, s62
    buffer_load_dwordx4 v3, s[24:27], s45 offen lds
    s_lshl_b32 s44, s62, 14
    s_add_u32 s44, s44, s57
    s_add_u32 m0, s55, 0
    s_add_u32 s45, s44, 8192
    buffer_load_dwordx4 v3, s[24:27], s44 offen lds
    s_add_u32 m0, s55, 1024
    s_add_u32 s62, s62, 1
    s_cmp_eq_u32 s62, 8
    s_cselect_b32 s62, 0, s62
    buffer_load_dwordx4 v3, s[24:27], s45 offen lds
    s_lshl_b32 s44, s62, 14
    s_add_u32 s44, s44, s57
    s_add_u32 m0, s55, 2048
    s_add_u32 s45, s44, 8192
    buffer_load_dwordx4 v3, s[24:27], s44 offen lds
    s_add_u32 m0, s55, 3072
    s_add_u32 s62, s62, 1
    s_cmp_eq_u32 s62, 8
    s_cselect_b32 s62, 0, s62
    buffer_load_dwordx4 v3, s[24:27], s45 offen lds
    s_lshl_b32 s44, s62, 14
    s_add_u32 s44, s44, s57
    s_add_u32 m0, s55, 4096
    s_add_u32 s45, s44, 8192
    buffer_load_dwordx4 v3, s[24:27], s44 offen lds
    s_add_u32 m0, s55, 5120
    s_add_u32 s62, s62, 1
    s_cmp_eq_u32 s62, 8
    s_cselect_b32 s62, 0, s62
    buffer_load_dwordx4 v3, s[24:27], s45 offen lds
    s_lshl_b32 s44, s62, 14
    s_add_u32 s44, s44, s57
    s_add_u32 m0, s55, 6144
    s_add_u32 s45, s44, 8192
    buffer_load_dwordx4 v3, s[24:27], s44 offen lds
    s_add_u32 m0, s55, 7168
    s_add_u32 s62, s62, 1
    s_cmp_eq_u32 s62, 8
    s_cselect_b32 s62, 0, s62
    buffer_load_dwordx4 v3, s[24:27], s45 offen lds
    s_lshl_b32 s44, s62, 14
    s_add_u32 s44, s44, s57
    s_add_u32 m0, s55, 8192
    s_add_u32 s45, s44, 8192
    buffer_load_dwordx4 v3, s[24:27], s44 offen lds
    s_add_u32 m0, s55, 9216
    s_add_u32 s62, s62, 1
    s_cmp_eq_u32 s62, 8
    s_cselect_b32 s62, 0, s62
    buffer_load_dwordx4 v3, s[24:27], s45 offen lds
    s_lshl_b32 s44, s62, 14
    s_add_u32 s44, s44, s57
    s_add_u32 m0, s52, 0
    s_add_u32 s45, s44, 8192
    buffer_load_dwordx4 v3, s[24:27], s44 offen lds
    s_add_u32 m0, s52, 1024
    s_add_u32 s62, s62, 1
    s_cmp_eq_u32 s62, 8
    s_cselect_b32 s62, 0, s62
    buffer_load_dwordx4 v3, s[24:27], s45 offen lds
    s_lshl_b32 s44, s62, 14
    s_add_u32 s44, s44, s57
    s_add_u32 m0, s52, 2048
    s_add_u32 s45, s44, 8192
    buffer_load_dwordx4 v3, s[24:27], s44 offen lds
    s_add_u32 m0, s52, 3072
    s_add_u32 s62, s62, 1
    s_cmp_eq_u32 s62, 8
    s_cselect_b32 s62, 0, s62
    buffer_load_dwordx4 v3, s[24:27], s45 offen lds
    v_mov_b32 v192, 0
    v_mov_b32 v193, 0
    v_mov_b32 v194, 0
    v_mov_b32 v195, 0
    v_mov_b32 v196, 0
    v_mov_b32 v197, 0
    v_mov_b32 v198, 0
    v_mov_b32 v199, 0
    v_mov_b32 v200, 0
    v_mov_b32 v201, 0
    v_mov_b32 v202, 0
    v_mov_b32 v203, 0
    v_mov_b32 v204, 0
    v_mov_b32 v205, 0
    v_mov_b32 v206, 0
    v_mov_b32 v207, 0
    v_mov_b32 v208, 0
    v_mov_b32 v209, 0
    v_mov_b32 v210, 0
    v_mov_b32 v211, 0
    v_mov_b32 v212, 0
    v_mov_b32 v213, 0
    v_mov_b32 v214, 0
    v_mov_b32 v215, 0
    v_mov_b32 v216, 0
    v_mov_b32 v217, 0
    v_mov_b32 v218, 0
    v_mov_b32 v219, 0
    v_mov_b32 v220, 0
    v_mov_b32 v221, 0
    v_mov_b32 v222, 0
    v_mov_b32 v223, 0
    v_mov_b32 v224, 0
    v_mov_b32 v225, 0
    v_mov_b32 v226, 0
    v_mov_b32 v227, 0
    v_mov_b32 v228, 0
    v_mov_b32 v229, 0
    v_mov_b32 v230, 0
    v_mov_b32 v231, 0
    v_mov_b32 v232, 0
    v_mov_b32 v233, 0
    v_mov_b32 v234, 0
    v_mov_b32 v235, 0
    v_mov_b32 v236, 0
    v_mov_b32 v237, 0
    v_mov_b32 v238, 0
    v_mov_b32 v239, 0
    v_mov_b32 v240, 0
    v_mov_b32 v241, 0
    v_mov_b32 v242, 0
    v_mov_b32 v243, 0
    v_mov_b32 v244, 0
    v_mov_b32 v245, 0
    v_mov_b32 v246, 0
    v_mov_b32 v247, 0
    v_mov_b32 v248, 0
    v_mov_b32 v249, 0
    v_mov_b32 v250, 0
    v_mov_b32 v251, 0
    v_mov_b32 v252, 0
    v_mov_b32 v253, 0
    v_mov_b32 v254, 0
    v_mov_b32 v255, 0
    v_and_b32 v14, 31, v0
    s_lshl_b32 s44, s40, 5
    v_add_u32 v14, s44, v14
    v_mul_u32_u24 v14, 32, v14
    v_add_u32 v14, 4096, v14
    s_mov_b32 s45, 0
L_P2_F1_pl:
    buffer_load_dwordx2 v[16:17], v14, s[28:31], 0 offen sc1
    s_add_u32 s45, s45, 1
    s_waitcnt vmcnt(0)
    v_cmp_ne_u32 vcc, s42, v16
    v_cmp_ne_u32 s[46:47], s43, v17
    s_nop 1
    s_or_b64 vcc, vcc, s[46:47]
    s_cmp_eq_u64 vcc, 0
    s_cbranch_scc1 L_P2_F1_ok
    s_cmp_ge_u32 s45, 16384
    s_cbranch_scc1 L_P2_F1_ok
    s_sleep 4
    s_branch L_P2_F1_pl
L_P2_F1_ok:
    s_mul_i32 s58, s40, 176128
    s_add_u32 s58, s58, 4194304
    s_mul_i32 s59, s49, 22
    s_mul_i32 s60, s40, 65536
    s_lshl_b32 s44, s49, 14
    s_add_u32 s60, s60, s44
    s_add_u32 s60, s60, 2097152
    s_mov_b32 s84, s83
    s_mov_b32 s85, s82
    s_add_u32 s44, s59, s84
    s_min_u32 s44, s44, 85
    s_lshl_b32 s44, s44, 11
    s_add_u32 s44, s44, s58
    s_add_u32 s84, s84, 1
    s_cmp_eq_u32 s84, 22
    s_cselect_b32 s84, 0, s84
    buffer_load_dwordx4 v[16:19], v2, s[28:31], s44 offen sc1
    buffer_load_dwordx4 v[20:23], v15, s[28:31], s44 offen sc1
    s_add_u32 s44, s59, s84
    s_min_u32 s44, s44, 85
    s_lshl_b32 s44, s44, 11
    s_add_u32 s44, s44, s58
    s_add_u32 s84, s84, 1
    s_cmp_eq_u32 s84, 22
    s_cselect_b32 s84, 0, s84
    buffer_load_dwordx4 v[24:27], v2, s[28:31], s44 offen sc1
    buffer_load_dwordx4 v[28:31], v15, s[28:31], s44 offen sc1
    s_add_u32 s44, s59, s84
    s_min_u32 s44, s44, 85
    s_lshl_b32 s44, s44, 11
    s_add_u32 s44, s44, s58
    s_add_u32 s84, s84, 1
    s_cmp_eq_u32 s84, 22
    s_cselect_b32 s84, 0, s84
    buffer_load_dwordx4 v[32:35], v2, s[28:31], s44 offen sc1
    buffer_load_dwordx4 v[36:39], v15, s[28:31], s44 offen sc1
    s_add_u32 s44, s59, s84
    s_min_u32 s44, s44, 85
    s_lshl_b32 s44, s44, 11
    s_add_u32 s44, s44, s58
    s_add_u32 s84, s84, 1
    s_cmp_eq_u32 s84, 22
    s_cselect_b32 s84, 0, s84
    buffer_load_dwordx4 v[40:43], v2, s[28:31], s44 offen sc1
    buffer_load_dwordx4 v[44:47], v15, s[28:31], s44 offen sc1
    s_add_u32 s44, s59, s84
    s_min_u32 s44, s44, 85
    s_lshl_b32 s44, s44, 11
    s_add_u32 s44, s44, s58
    s_add_u32 s84, s84, 1
    s_cmp_eq_u32 s84, 22
    s_cselect_b32 s84, 0, s84
    buffer_load_dwordx4 v[48:51], v2, s[28:31], s44 offen sc1
    buffer_load_dwordx4 v[52:55], v15, s[28:31], s44 offen sc1
    s_add_u32 s44, s59, s84
    s_min_u32 s44, s44, 85
    s_lshl_b32 s44, s44, 11
    s_add_u32 s44, s44, s58
    s_add_u32 s84, s84, 1
    s_cmp_eq_u32 s84, 22
    s_cselect_b32 s84, 0, s84
    buffer_load_dwordx4 v[56:59], v2, s[28:31], s44 offen sc1
    buffer_load_dwordx4 v[60:63], v15, s[28:31], s44 offen sc1
    s_waitcnt vmcnt(10)
    v_mfma_f32_32x32x16_bf16 v[192:207], v[64:67], v[16:19], v[192:207]
    v_mfma_f32_32x32x16_bf16 v[208:223], v[64:67], v[20:23], v[208:223]
    v_mfma_f32_32x32x16_bf16 v[224:239], v[68:71], v[16:19], v[224:239]
    v_mfma_f32_32x32x16_bf16 v[240:255], v[68:71], v[20:23], v[240:255]
    s_add_u32 s44, s59, s84
    s_min_u32 s44, s44, 85
    s_lshl_b32 s44, s44, 11
    s_add_u32 s44, s44, s58
    s_add_u32 s84, s84, 1
    s_cmp_eq_u32 s84, 22
    s_cselect_b32 s84, 0, s84
    buffer_load_dwordx4 v[16:19], v2, s[28:31], s44 offen sc1
    buffer_load_dwordx4 v[20:23], v15, s[28:31], s44 offen sc1
    s_waitcnt vmcnt(10)
    v_mfma_f32_32x32x16_bf16 v[192:207], v[72:75], v[24:27], v[192:207]
    v_mfma_f32_32x32x16_bf16 v[208:223], v[72:75], v[28:31], v[208:223]
    v_mfma_f32_32x32x16_bf16 v[224:239], v[76:79], v[24:27], v[224:239]
    v_mfma_f32_32x32x16_bf16 v[240:255], v[76:79], v[28:31], v[240:255]
    s_add_u32 s44, s59, s84
    s_min_u32 s44, s44, 85
    s_lshl_b32 s44, s44, 11
    s_add_u32 s44, s44, s58
    s_add_u32 s84, s84, 1
    s_cmp_eq_u32 s84, 22
    s_cselect_b32 s84, 0, s84
    buffer_load_dwordx4 v[24:27], v2, s[28:31], s44 offen sc1
    buffer_load_dwordx4 v[28:31], v15, s[28:31], s44 offen sc1
    s_waitcnt vmcnt(10)
    v_mfma_f32_32x32x16_bf16 v[192:207], v[80:83], v[32:35], v[192:207]
    v_mfma_f32_32x32x16_bf16 v[208:223], v[80:83], v[36:39], v[208:223]
    v_mfma_f32_32x32x16_bf16 v[224:239], v[84:87], v[32:35], v[224:239]
    v_mfma_f32_32x32x16_bf16 v[240:255], v[84:87], v[36:39], v[240:255]
    s_add_u32 s44, s59, s84
    s_min_u32 s44, s44, 85
    s_lshl_b32 s44, s44, 11
    s_add_u32 s44, s44, s58
    s_add_u32 s84, s84, 1
    s_cmp_eq_u32 s84, 22
    s_cselect_b32 s84, 0, s84
    buffer_load_dwordx4 v[32:35], v2, s[28:31], s44 offen sc1
    buffer_load_dwordx4 v[36:39], v15, s[28:31], s44 offen sc1
    s_waitcnt vmcnt(10)
    v_mfma_f32_32x32x16_bf16 v[192:207], v[88:91], v[40:43], v[192:207]
    v_mfma_f32_32x32x16_bf16 v[208:223], v[88:91], v[44:47], v[208:223]
    v_mfma_f32_32x32x16_bf16 v[224:239], v[92:95], v[40:43], v[224:239]
    v_mfma_f32_32x32x16_bf16 v[240:255], v[92:95], v[44:47], v[240:255]
    s_add_u32 s44, s59, s84
    s_min_u32 s44, s44, 85
    s_lshl_b32 s44, s44, 11
    s_add_u32 s44, s44, s58
    s_add_u32 s84, s84, 1
    s_cmp_eq_u32 s84, 22
    s_cselect_b32 s84, 0, s84
    buffer_load_dwordx4 v[40:43], v2, s[28:31], s44 offen sc1
    buffer_load_dwordx4 v[44:47], v15, s[28:31], s44 offen sc1
    s_waitcnt vmcnt(10)
    v_mfma_f32_32x32x16_bf16 v[192:207], v[96:99], v[48:51], v[192:207]
    v_mfma_f32_32x32x16_bf16 v[208:223], v[96:99], v[52:55], v[208:223]
    v_mfma_f32_32x32x16_bf16 v[224:239], v[100:103], v[48:51], v[224:239]
    v_mfma_f32_32x32x16_bf16 v[240:255], v[100:103], v[52:55], v[240:255]
    s_add_u32 s44, s59, s84
    s_min_u32 s44, s44, 85
    s_lshl_b32 s44, s44, 11
    s_add_u32 s44, s44, s58
    s_add_u32 s84, s84, 1
    s_cmp_eq_u32 s84, 22
    s_cselect_b32 s84, 0, s84
    buffer_load_dwordx4 v[48:51], v2, s[28:31], s44 offen sc1
    buffer_load_dwordx4 v[52:55], v15, s[28:31], s44 offen sc1
    s_waitcnt vmcnt(10)
    v_mfma_f32_32x32x16_bf16 v[192:207], v[104:107], v[56:59], v[192:207]
    v_mfma_f32_32x32x16_bf16 v[208:223], v[104:107], v[60:63], v[208:223]
    v_mfma_f32_32x32x16_bf16 v[224:239], v[108:111], v[56:59], v[224:239]
    v_mfma_f32_32x32x16_bf16 v[240:255], v[108:111], v[60:63], v[240:255]
    s_add_u32 s44, s59, s84
    s_min_u32 s44, s44, 85
    s_lshl_b32 s44, s44, 11
    s_add_u32 s44, s44, s58
    s_add_u32 s84, s84, 1
    s_cmp_eq_u32 s84, 22
    s_cselect_b32 s84, 0, s84
    buffer_load_dwordx4 v[56:59], v2, s[28:31], s44 offen sc1
    buffer_load_dwordx4 v[60:63], v15, s[28:31], s44 offen sc1
    s_waitcnt vmcnt(10)
    v_mfma_f32_32x32x16_bf16 v[192:207], v[112:115], v[16:19], v[192:207]
    v_mfma_f32_32x32x16_bf16 v[208:223], v[112:115], v[20:23], v[208:223]
    v_mfma_f32_32x32x16_bf16 v[224:239], v[116:119], v[16:19], v[224:239]
    v_mfma_f32_32x32x16_bf16 v[240:255], v[116:119], v[20:23], v[240:255]
    s_add_u32 s44, s59, s84
    s_min_u32 s44, s44, 85
    s_lshl_b32 s44, s44, 11
    s_add_u32 s44, s44, s58
    s_add_u32 s84, s84, 1
    s_cmp_eq_u32 s84, 22
    s_cselect_b32 s84, 0, s84
    buffer_load_dwordx4 v[16:19], v2, s[28:31], s44 offen sc1
    buffer_load_dwordx4 v[20:23], v15, s[28:31], s44 offen sc1
    s_waitcnt vmcnt(10)
    v_mfma_f32_32x32x16_bf16 v[192:207], v[120:123], v[24:27], v[192:207]
    v_mfma_f32_32x32x16_bf16 v[208:223], v[120:123], v[28:31], v[208:223]
    v_mfma_f32_32x32x16_bf16 v[224:239], v[124:127], v[24:27], v[224:239]
    v_mfma_f32_32x32x16_bf16 v[240:255], v[124:127], v[28:31], v[240:255]
    s_add_u32 s44, s59, s84
    s_min_u32 s44, s44, 85
    s_lshl_b32 s44, s44, 11
    s_add_u32 s44, s44, s58
    s_add_u32 s84, s84, 1
    s_cmp_eq_u32 s84, 22
    s_cselect_b32 s84, 0, s84
    buffer_load_dwordx4 v[24:27], v2, s[28:31], s44 offen sc1
    buffer_load_dwordx4 v[28:31], v15, s[28:31], s44 offen sc1
    s_waitcnt vmcnt(10)
    v_mfma_f32_32x32x16_bf16 v[192:207], v[128:131], v[32:35], v[192:207]
    v_mfma_f32_32x32x16_bf16 v[208:223], v[128:131], v[36:39], v[208:223]
    v_mfma_f32_32x32x16_bf16 v[224:239], v[132:135], v[32:35], v[224:239]
    v_mfma_f32_32x32x16_bf16 v[240:255], v[132:135], v[36:39], v[240:255]
    s_add_u32 s44, s59, s84
    s_min_u32 s44, s44, 85
    s_lshl_b32 s44, s44, 11
    s_add_u32 s44, s44, s58
    s_add_u32 s84, s84, 1
    s_cmp_eq_u32 s84, 22
    s_cselect_b32 s84, 0, s84
    buffer_load_dwordx4 v[32:35], v2, s[28:31], s44 offen sc1
    buffer_load_dwordx4 v[36:39], v15, s[28:31], s44 offen sc1
    s_waitcnt vmcnt(10)
    v_mfma_f32_32x32x16_bf16 v[192:207], v[136:139], v[40:43], v[192:207]
    v_mfma_f32_32x32x16_bf16 v[208:223], v[136:139], v[44:47], v[208:223]
    v_mfma_f32_32x32x16_bf16 v[224:239], v[140:143], v[40:43], v[224:239]
    v_mfma_f32_32x32x16_bf16 v[240:255], v[140:143], v[44:47], v[240:255]
    s_add_u32 s44, s59, s84
    s_min_u32 s44, s44, 85
    s_lshl_b32 s44, s44, 11
    s_add_u32 s44, s44, s58
    s_add_u32 s84, s84, 1
    s_cmp_eq_u32 s84, 22
    s_cselect_b32 s84, 0, s84
    buffer_load_dwordx4 v[40:43], v2, s[28:31], s44 offen sc1
    buffer_load_dwordx4 v[44:47], v15, s[28:31], s44 offen sc1
    s_waitcnt vmcnt(10)
    v_mfma_f32_32x32x16_bf16 v[192:207], v[144:147], v[48:51], v[192:207]
    v_mfma_f32_32x32x16_bf16 v[208:223], v[144:147], v[52:55], v[208:223]
    v_mfma_f32_32x32x16_bf16 v[224:239], v[148:151], v[48:51], v[224:239]
    v_mfma_f32_32x32x16_bf16 v[240:255], v[148:151], v[52:55], v[240:255]
    v_and_b32 v160, 15, v0
    s_lshl_b32 s44, s40, 4
    v_add_u32 v160, s44, v160
    v_mul_u32_u24 v160, 32, v160
    v_add_u32 v160, 36864, v160
    buffer_load_dwordx2 v[162:163], v160, s[28:31], 0 offen sc1
    s_add_u32 s44, s59, s84
    s_min_u32 s44, s44, 85
    s_lshl_b32 s44, s44, 11
    s_add_u32 s44, s44, s58
    s_add_u32 s84, s84, 1
    s_cmp_eq_u32 s84, 22
    s_cselect_b32 s84, 0, s84
    buffer_load_dwordx4 v[48:51], v2, s[28:31], s44 offen sc1
    buffer_load_dwordx4 v[52:55], v15, s[28:31], s44 offen sc1
    s_waitcnt vmcnt(11)
    v_mfma_f32_32x32x16_bf16 v[192:207], v[152:155], v[56:59], v[192:207]
    ds_read_b64_tr_b16 v[64:65], v4 offset:6144
    v_mfma_f32_32x32x16_bf16 v[208:223], v[152:155], v[60:63], v[208:223]
    ds_read_b64_tr_b16 v[66:67], v4 offset:7168
    v_mfma_f32_32x32x16_bf16 v[224:239], v[156:159], v[56:59], v[224:239]
    ds_read_b64_tr_b16 v[68:69], v5 offset:6144
    v_mfma_f32_32x32x16_bf16 v[240:255], v[156:159], v[60:63], v[240:255]
    ds_read_b64_tr_b16 v[70:71], v5 offset:7168
    s_add_u32 s44, s59, s84
    s_min_u32 s44, s44, 85
    s_lshl_b32 s44, s44, 11
    s_add_u32 s44, s44, s58
    s_add_u32 s84, s84, 1
    s_cmp_eq_u32 s84, 22
    s_cselect_b32 s84, 0, s84
    buffer_load_dwordx4 v[56:59], v2, s[28:31], s44 offen sc1
    buffer_load_dwordx4 v[60:63], v15, s[28:31], s44 offen sc1
    s_waitcnt vmcnt(11)
    s_waitcnt lgkmcnt(0)
    v_mfma_f32_32x32x16_bf16 v[192:207], v[64:67], v[16:19], v[192:207]
    ds_read_b64_tr_b16 v[72:73], v6 offset:0
    v_mfma_f32_32x32x16_bf16 v[208:223], v[64:67], v[20:23], v[208:223]
    ds_read_b64_tr_b16 v[74:75], v6 offset:1024
    v_mfma_f32_32x32x16_bf16 v[224:239], v[68:71], v[16:19], v[224:239]
    ds_read_b64_tr_b16 v[76:77], v7 offset:0
    v_mfma_f32_32x32x16_bf16 v[240:255], v[68:71], v[20:23], v[240:255]
    ds_read_b64_tr_b16 v[78:79], v7 offset:1024
    s_add_u32 s44, s59, s84
    s_min_u32 s44, s44, 85
    s_lshl_b32 s44, s44, 11
    s_add_u32 s44, s44, s58
    s_add_u32 s84, s84, 1
    s_cmp_eq_u32 s84, 22
    s_cselect_b32 s84, 0, s84
    buffer_load_dwordx4 v[16:19], v2, s[28:31], s44 offen sc1
    buffer_load_dwordx4 v[20:23], v15, s[28:31], s44 offen sc1
    s_waitcnt vmcnt(11)
    s_waitcnt lgkmcnt(0)
    v_mfma_f32_32x32x16_bf16 v[192:207], v[72:75], v[24:27], v[192:207]
    ds_read_b64_tr_b16 v[64:65], v6 offset:2048
    v_mfma_f32_32x32x16_bf16 v[208:223], v[72:75], v[28:31], v[208:223]
    ds_read_b64_tr_b16 v[66:67], v6 offset:3072
    v_mfma_f32_32x32x16_bf16 v[224:239], v[76:79], v[24:27], v[224:239]
    ds_read_b64_tr_b16 v[68:69], v7 offset:2048
    v_mfma_f32_32x32x16_bf16 v[240:255], v[76:79], v[28:31], v[240:255]
    ds_read_b64_tr_b16 v[70:71], v7 offset:3072
    s_add_u32 s44, s59, s84
    s_min_u32 s44, s44, 85
    s_lshl_b32 s44, s44, 11
    s_add_u32 s44, s44, s58
    s_add_u32 s84, s84, 1
    s_cmp_eq_u32 s84, 22
    s_cselect_b32 s84, 0, s84
    buffer_load_dwordx4 v[24:27], v2, s[28:31], s44 offen sc1
    buffer_load_dwordx4 v[28:31], v15, s[28:31], s44 offen sc1
    s_waitcnt vmcnt(11)
    s_waitcnt lgkmcnt(0)
    v_mfma_f32_32x32x16_bf16 v[192:207], v[64:67], v[32:35], v[192:207]
    ds_read_b64_tr_b16 v[72:73], v6 offset:4096
    v_mfma_f32_32x32x16_bf16 v[208:223], v[64:67], v[36:39], v[208:223]
    ds_read_b64_tr_b16 v[74:75], v6 offset:5120
    v_mfma_f32_32x32x16_bf16 v[224:239], v[68:71], v[32:35], v[224:239]
    ds_read_b64_tr_b16 v[76:77], v7 offset:4096
    v_mfma_f32_32x32x16_bf16 v[240:255], v[68:71], v[36:39], v[240:255]
    ds_read_b64_tr_b16 v[78:79], v7 offset:5120
    s_add_u32 s44, s59, s84
    s_min_u32 s44, s44, 85
    s_lshl_b32 s44, s44, 11
    s_add_u32 s44, s44, s58
    s_add_u32 s84, s84, 1
    s_cmp_eq_u32 s84, 22
    s_cselect_b32 s84, 0, s84
    buffer_load_dwordx4 v[32:35], v2, s[28:31], s44 offen sc1
    buffer_load_dwordx4 v[36:39], v15, s[28:31], s44 offen sc1
    v_lshrrev_b32 v14, 5, v0
    v_lshlrev_b32 v14, 9, v14
    v_and_b32 v13, 31, v0
    v_lshl_add_u32 v14, v13, 4, v14
    s_lshl_b32 s46, s49, 14
    s_add_u32 s46, s46, 65536
    s_mov_b32 s47, s82
    s_mov_b32 exec_lo, 0x00ffffff
    s_mov_b32 exec_hi, 0x00ffffff
    s_lshl_b32 s44, s47, 11
    s_add_u32 s44, s44, s46
    buffer_load_dwordx4 v[80:83], v14, s[28:31], s44 offen sc1
    buffer_load_dwordx4 v[84:87], v14, s[28:31], s44 offen offset:1024 sc1
    s_add_u32 s47, s47, 1
    s_cmp_eq_u32 s47, 8
    s_cselect_b32 s47, 0, s47
    s_lshl_b32 s44, s47, 11
    s_add_u32 s44, s44, s46
    buffer_load_dwordx4 v[88:91], v14, s[28:31], s44 offen sc1
    buffer_load_dwordx4 v[92:95], v14, s[28:31], s44 offen offset:1024 sc1
    s_add_u32 s47, s47, 1
    s_cmp_eq_u32 s47, 8
    s_cselect_b32 s47, 0, s47
    s_lshl_b32 s44, s47, 11
    s_add_u32 s44, s44, s46
    buffer_load_dwordx4 v[96:99], v14, s[28:31], s44 offen sc1
    buffer_load_dwordx4 v[100:103], v14, s[28:31], s44 offen offset:1024 sc1
    s_add_u32 s47, s47, 1
    s_cmp_eq_u32 s47, 8
    s_cselect_b32 s47, 0, s47
    s_lshl_b32 s44, s47, 11
    s_add_u32 s44, s44, s46
    buffer_load_dwordx4 v[104:107], v14, s[28:31], s44 offen sc1
    buffer_load_dwordx4 v[108:111], v14, s[28:31], s44 offen offset:1024 sc1
    s_add_u32 s47, s47, 1
    s_cmp_eq_u32 s47, 8
    s_cselect_b32 s47, 0, s47
    s_lshl_b32 s44, s47, 11
    s_add_u32 s44, s44, s46
    buffer_load_dwordx4 v[112:115], v14, s[28:31], s44 offen sc1
    buffer_load_dwordx4 v[116:119], v14, s[28:31], s44 offen offset:1024 sc1
    s_add_u32 s47, s47, 1
    s_cmp_eq_u32 s47, 8
    s_cselect_b32 s47, 0, s47
    s_lshl_b32 s44, s47, 11
    s_add_u32 s44, s44, s46
    buffer_load_dwordx4 v[120:123], v14, s[28:31], s44 offen sc1
    buffer_load_dwordx4 v[124:127], v14, s[28:31], s44 offen offset:1024 sc1
    s_add_u32 s47, s47, 1
    s_cmp_eq_u32 s47, 8
    s_cselect_b32 s47, 0, s47
    s_lshl_b32 s44, s47, 11
    s_add_u32 s44, s44, s46
    buffer_load_dwordx4 v[128:131], v14, s[28:31], s44 offen sc1
    buffer_load_dwordx4 v[132:135], v14, s[28:31], s44 offen offset:1024 sc1
    s_add_u32 s47, s47, 1
    s_cmp_eq_u32 s47, 8
    s_cselect_b32 s47, 0, s47
    s_lshl_b32 s44, s47, 11
    s_add_u32 s44, s44, s46
    buffer_load_dwordx4 v[136:139], v14, s[28:31], s44 offen sc1
    buffer_load_dwordx4 v[140:143], v14, s[28:31], s44 offen offset:1024 sc1
    s_add_u32 s47, s47, 1
    s_cmp_eq_u32 s47, 8
    s_cselect_b32 s47, 0, s47
    s_mov_b64 exec, -1
    s_waitcnt vmcnt(27)
    s_waitcnt lgkmcnt(0)
    v_mfma_f32_32x32x16_bf16 v[192:207], v[72:75], v[40:43], v[192:207]
    ds_read_b64_tr_b16 v[64:65], v6 offset:6144
    v_mfma_f32_32x32x16_bf16 v[208:223], v[72:75], v[44:47], v[208:223]
    ds_read_b64_tr_b16 v[66:67], v6 offset:7168
    v_mfma_f32_32x32x16_bf16 v[224:239], v[76:79], v[40:43], v[224:239]
    ds_read_b64_tr_b16 v[68:69], v7 offset:6144
    v_mfma_f32_32x32x16_bf16 v[240:255], v[76:79], v[44:47], v[240:255]
    ds_read_b64_tr_b16 v[70:71], v7 offset:7168
    s_add_u32 s44, s59, s84
    s_min_u32 s44, s44, 85
    s_lshl_b32 s44, s44, 11
    s_add_u32 s44, s44, s58
    s_add_u32 s84, s84, 1
    s_cmp_eq_u32 s84, 22
    s_cselect_b32 s84, 0, s84
    buffer_load_dwordx4 v[40:43], v2, s[28:31], s44 offen sc1
    buffer_load_dwordx4 v[44:47], v15, s[28:31], s44 offen sc1
    s_waitcnt vmcnt(26)
    s_waitcnt lgkmcnt(0)
    v_mfma_f32_32x32x16_bf16 v[192:207], v[64:67], v[48:51], v[192:207]
    ds_read_b64_tr_b16 v[72:73], v6 offset:8192
    v_mfma_f32_32x32x16_bf16 v[208:223], v[64:67], v[52:55], v[208:223]
    ds_read_b64_tr_b16 v[74:75], v6 offset:9216
    v_mfma_f32_32x32x16_bf16 v[224:239], v[68:71], v[48:51], v[224:239]
    ds_read_b64_tr_b16 v[76:77], v7 offset:8192
    v_mfma_f32_32x32x16_bf16 v[240:255], v[68:71], v[52:55], v[240:255]
    ds_read_b64_tr_b16 v[78:79], v7 offset:9216
    v_xor_b32 v162, s42, v162
    v_xor_b32 v163, s43, v163
    v_or_b32 v162, v162, v163
    v_cmp_ne_u32 vcc, 0, v162
    s_nop 1
    s_cmp_eq_u64 vcc, 0
    s_cbranch_scc1 L_P2_F2OK
    s_mov_b32 s45, 0
L_P2_F2_pl:
    buffer_load_dwordx2 v[162:163], v160, s[28:31], 0 offen sc1
    s_add_u32 s45, s45, 1
    s_waitcnt vmcnt(0)
    v_cmp_ne_u32 vcc, s42, v162
    v_cmp_ne_u32 s[46:47], s43, v163
    s_nop 1
    s_or_b64 vcc, vcc, s[46:47]
    s_cmp_eq_u64 vcc, 0
    s_cbranch_scc1 L_P2_F2_ok
    s_cmp_ge_u32 s45, 16384
    s_cbranch_scc1 L_P2_F2_ok
    s_sleep 1
    s_branch L_P2_F2_pl
L_P2_F2_ok:
L_P2_F2OK:
    s_lshl_b32 s44, s85, 11
    s_add_u32 s44, s44, s60
    s_add_u32 s85, s85, 1
    s_cmp_eq_u32 s85, 8
    s_cselect_b32 s85, 0, s85
    buffer_load_dwordx4 v[48:51], v2, s[28:31], s44 offen sc1
    buffer_load_dwordx4 v[52:55], v15, s[28:31], s44 offen sc1
    s_waitcnt vmcnt(26)
    s_waitcnt lgkmcnt(0)
    v_mfma_f32_32x32x16_bf16 v[192:207], v[72:75], v[56:59], v[192:207]
    ds_read_b64_tr_b16 v[64:65], v8 offset:0
    v_mfma_f32_32x32x16_bf16 v[208:223], v[72:75], v[60:63], v[208:223]
    ds_read_b64_tr_b16 v[66:67], v8 offset:1024
    v_mfma_f32_32x32x16_bf16 v[224:239], v[76:79], v[56:59], v[224:239]
    ds_read_b64_tr_b16 v[68:69], v9 offset:0
    v_mfma_f32_32x32x16_bf16 v[240:255], v[76:79], v[60:63], v[240:255]
    ds_read_b64_tr_b16 v[70:71], v9 offset:1024
    s_lshl_b32 s44, s85, 11
    s_add_u32 s44, s44, s60
    s_add_u32 s85, s85, 1
    s_cmp_eq_u32 s85, 8
    s_cselect_b32 s85, 0, s85
    buffer_load_dwordx4 v[56:59], v2, s[28:31], s44 offen sc1
    buffer_load_dwordx4 v[60:63], v15, s[28:31], s44 offen sc1
    s_waitcnt vmcnt(26)
    s_waitcnt lgkmcnt(0)
    v_mfma_f32_32x32x16_bf16 v[192:207], v[64:67], v[16:19], v[192:207]
    ds_read_b64_tr_b16 v[72:73], v8 offset:2048
    v_mfma_f32_32x32x16_bf16 v[208:223], v[64:67], v[20:23], v[208:223]
    ds_read_b64_tr_b16 v[74:75], v8 offset:3072
    v_mfma_f32_32x32x16_bf16 v[224:239], v[68:71], v[16:19], v[224:239]
    ds_read_b64_tr_b16 v[76:77], v9 offset:2048
    v_mfma_f32_32x32x16_bf16 v[240:255], v[68:71], v[20:23], v[240:255]
    ds_read_b64_tr_b16 v[78:79], v9 offset:3072
    s_lshl_b32 s44, s85, 11
    s_add_u32 s44, s44, s60
    s_add_u32 s85, s85, 1
    s_cmp_eq_u32 s85, 8
    s_cselect_b32 s85, 0, s85
    buffer_load_dwordx4 v[16:19], v2, s[28:31], s44 offen sc1
    buffer_load_dwordx4 v[20:23], v15, s[28:31], s44 offen sc1
    s_waitcnt vmcnt(26)
    s_waitcnt lgkmcnt(0)
    v_mfma_f32_32x32x16_bf16 v[192:207], v[72:75], v[24:27], v[192:207]
    ds_read_b64_tr_b16 v[64:65], v8 offset:4096
    v_mfma_f32_32x32x16_bf16 v[208:223], v[72:75], v[28:31], v[208:223]
    ds_read_b64_tr_b16 v[66:67], v8 offset:5120
    v_mfma_f32_32x32x16_bf16 v[224:239], v[76:79], v[24:27], v[224:239]
    ds_read_b64_tr_b16 v[68:69], v9 offset:4096
    v_mfma_f32_32x32x16_bf16 v[240:255], v[76:79], v[28:31], v[240:255]
    ds_read_b64_tr_b16 v[70:71], v9 offset:5120
    s_lshl_b32 s44, s85, 11
    s_add_u32 s44, s44, s60
    s_add_u32 s85, s85, 1
    s_cmp_eq_u32 s85, 8
    s_cselect_b32 s85, 0, s85
    buffer_load_dwordx4 v[24:27], v2, s[28:31], s44 offen sc1
    buffer_load_dwordx4 v[28:31], v15, s[28:31], s44 offen sc1
    s_waitcnt vmcnt(26)
    s_waitcnt lgkmcnt(0)
    v_mfma_f32_32x32x16_bf16 v[192:207], v[64:67], v[32:35], v[192:207]
    ds_read_b64_tr_b16 v[72:73], v8 offset:6144
    v_mfma_f32_32x32x16_bf16 v[208:223], v[64:67], v[36:39], v[208:223]
    ds_read_b64_tr_b16 v[74:75], v8 offset:7168
    v_mfma_f32_32x32x16_bf16 v[224:239], v[68:71], v[32:35], v[224:239]
    ds_read_b64_tr_b16 v[76:77], v9 offset:6144
    v_mfma_f32_32x32x16_bf16 v[240:255], v[68:71], v[36:39], v[240:255]
    ds_read_b64_tr_b16 v[78:79], v9 offset:7168
    s_lshl_b32 s44, s85, 11
    s_add_u32 s44, s44, s60
    s_add_u32 s85, s85, 1
    s_cmp_eq_u32 s85, 8
    s_cselect_b32 s85, 0, s85
    buffer_load_dwordx4 v[32:35], v2, s[28:31], s44 offen sc1
    buffer_load_dwordx4 v[36:39], v15, s[28:31], s44 offen sc1
    s_waitcnt vmcnt(10)
    s_waitcnt lgkmcnt(0)
    v_mfma_f32_32x32x16_bf16 v[192:207], v[72:75], v[40:43], v[192:207]
    ds_read_b64_tr_b16 v[64:65], v8 offset:8192
    v_mfma_f32_32x32x16_bf16 v[208:223], v[72:75], v[44:47], v[208:223]
    ds_read_b64_tr_b16 v[66:67], v8 offset:9216
    v_mfma_f32_32x32x16_bf16 v[224:239], v[76:79], v[40:43], v[224:239]
    ds_read_b64_tr_b16 v[68:69], v9 offset:8192
    v_mfma_f32_32x32x16_bf16 v[240:255], v[76:79], v[44:47], v[240:255]
    ds_read_b64_tr_b16 v[70:71], v9 offset:9216
    s_lshl_b32 s44, s85, 11
    s_add_u32 s44, s44, s60
    s_add_u32 s85, s85, 1
    s_cmp_eq_u32 s85, 8
    s_cselect_b32 s85, 0, s85
    buffer_load_dwordx4 v[40:43], v2, s[28:31], s44 offen sc1
    buffer_load_dwordx4 v[44:47], v15, s[28:31], s44 offen sc1
    s_mov_b32 s48, 0
L_KV_CHK:
    v_xor_b32 v13, s42, v82
    v_xor_b32 v1, s43, v83
    v_or_b32 v13, v13, v1
    v_xor_b32 v1, s42, v86
    v_or_b32 v13, v13, v1
    v_xor_b32 v1, s43, v87
    v_or_b32 v13, v13, v1
    v_xor_b32 v1, s42, v90
    v_or_b32 v13, v13, v1
    v_xor_b32 v1, s43, v91
    v_or_b32 v13, v13, v1
    v_xor_b32 v1, s42, v94
    v_or_b32 v13, v13, v1
    v_xor_b32 v1, s43, v95
    v_or_b32 v13, v13, v1
    v_xor_b32 v1, s42, v98
    v_or_b32 v13, v13, v1
    v_xor_b32 v1, s43, v99
    v_or_b32 v13, v13, v1
    v_xor_b32 v1, s42, v102
    v_or_b32 v13, v13, v1
    v_xor_b32 v1, s43, v103
    v_or_b32 v13, v13, v1
    v_xor_b32 v1, s42, v106
    v_or_b32 v13, v13, v1
    v_xor_b32 v1, s43, v107
    v_or_b32 v13, v13, v1
    v_xor_b32 v1, s42, v110
    v_or_b32 v13, v13, v1
    v_xor_b32 v1, s43, v111
    v_or_b32 v13, v13, v1
    v_xor_b32 v1, s42, v114
    v_or_b32 v13, v13, v1
    v_xor_b32 v1, s43, v115
    v_or_b32 v13, v13, v1
    v_xor_b32 v1, s42, v118
    v_or_b32 v13, v13, v1
    v_xor_b32 v1, s43, v119
    v_or_b32 v13, v13, v1
    v_xor_b32 v1, s42, v122
    v_or_b32 v13, v13, v1
    v_xor_b32 v1, s43, v123
    v_or_b32 v13, v13, v1
    v_xor_b32 v1, s42, v126
    v_or_b32 v13, v13, v1
    v_xor_b32 v1, s43, v127
    v_or_b32 v13, v13, v1
    v_xor_b32 v1, s42, v130
    v_or_b32 v13, v13, v1
    v_xor_b32 v1, s43, v131
    v_or_b32 v13, v13, v1
    v_xor_b32 v1, s42, v134
    v_or_b32 v13, v13, v1
    v_xor_b32 v1, s43, v135
    v_or_b32 v13, v13, v1
    v_xor_b32 v1, s42, v138
    v_or_b32 v13, v13, v1
    v_xor_b32 v1, s43, v139
    v_or_b32 v13, v13, v1
    v_xor_b32 v1, s42, v142
    v_or_b32 v13, v13, v1
    v_xor_b32 v1, s43, v143
    v_or_b32 v13, v13, v1
    v_cmp_ne_u32 vcc, 0, v13
    s_nop 1
    s_and_b32 vcc_lo, vcc_lo, 0x0011ffff
    s_and_b32 vcc_hi, vcc_hi, 0x0011ffff
    s_add_u32 s48, s48, 1
    s_cmp_eq_u64 vcc, 0
    s_cbranch_scc1 L_KV_OK
    s_cmp_ge_u32 s48, 8192
    s_cbranch_scc1 L_KV_OK
    s_sleep 8
    v_lshrrev_b32 v14, 5, v0
    v_lshlrev_b32 v14, 9, v14
    v_and_b32 v13, 31, v0
    v_lshl_add_u32 v14, v13, 4, v14
    s_lshl_b32 s46, s49, 14
    s_add_u32 s46, s46, 65536
    s_mov_b32 s47, s82
    s_mov_b32 exec_lo, 0x00ffffff
    s_mov_b32 exec_hi, 0x00ffffff
    s_lshl_b32 s44, s47, 11
    s_add_u32 s44, s44, s46
    buffer_load_dwordx4 v[80:83], v14, s[28:31], s44 offen sc1
    buffer_load_dwordx4 v[84:87], v14, s[28:31], s44 offen offset:1024 sc1
    s_add_u32 s47, s47, 1
    s_cmp_eq_u32 s47, 8
    s_cselect_b32 s47, 0, s47
    s_lshl_b32 s44, s47, 11
    s_add_u32 s44, s44, s46
    buffer_load_dwordx4 v[88:91], v14, s[28:31], s44 offen sc1
    buffer_load_dwordx4 v[92:95], v14, s[28:31], s44 offen offset:1024 sc1
    s_add_u32 s47, s47, 1
    s_cmp_eq_u32 s47, 8
    s_cselect_b32 s47, 0, s47
    s_lshl_b32 s44, s47, 11
    s_add_u32 s44, s44, s46
    buffer_load_dwordx4 v[96:99], v14, s[28:31], s44 offen sc1
    buffer_load_dwordx4 v[100:103], v14, s[28:31], s44 offen offset:1024 sc1
    s_add_u32 s47, s47, 1
    s_cmp_eq_u32 s47, 8
    s_cselect_b32 s47, 0, s47
    s_lshl_b32 s44, s47, 11
    s_add_u32 s44, s44, s46
    buffer_load_dwordx4 v[104:107], v14, s[28:31], s44 offen sc1
    buffer_load_dwordx4 v[108:111], v14, s[28:31], s44 offen offset:1024 sc1
    s_add_u32 s47, s47, 1
    s_cmp_eq_u32 s47, 8
    s_cselect_b32 s47, 0, s47
    s_lshl_b32 s44, s47, 11
    s_add_u32 s44, s44, s46
    buffer_load_dwordx4 v[112:115], v14, s[28:31], s44 offen sc1
    buffer_load_dwordx4 v[116:119], v14, s[28:31], s44 offen offset:1024 sc1
    s_add_u32 s47, s47, 1
    s_cmp_eq_u32 s47, 8
    s_cselect_b32 s47, 0, s47
    s_lshl_b32 s44, s47, 11
    s_add_u32 s44, s44, s46
    buffer_load_dwordx4 v[120:123], v14, s[28:31], s44 offen sc1
    buffer_load_dwordx4 v[124:127], v14, s[28:31], s44 offen offset:1024 sc1
    s_add_u32 s47, s47, 1
    s_cmp_eq_u32 s47, 8
    s_cselect_b32 s47, 0, s47
    s_lshl_b32 s44, s47, 11
    s_add_u32 s44, s44, s46
    buffer_load_dwordx4 v[128:131], v14, s[28:31], s44 offen sc1
    buffer_load_dwordx4 v[132:135], v14, s[28:31], s44 offen offset:1024 sc1
    s_add_u32 s47, s47, 1
    s_cmp_eq_u32 s47, 8
    s_cselect_b32 s47, 0, s47
    s_lshl_b32 s44, s47, 11
    s_add_u32 s44, s44, s46
    buffer_load_dwordx4 v[136:139], v14, s[28:31], s44 offen sc1
    buffer_load_dwordx4 v[140:143], v14, s[28:31], s44 offen offset:1024 sc1
    s_add_u32 s47, s47, 1
    s_cmp_eq_u32 s47, 8
    s_cselect_b32 s47, 0, s47
    s_mov_b64 exec, -1
    s_waitcnt vmcnt(0)
    s_branch L_KV_CHK
L_KV_OK:
    v_mov_b32 v160, v80
    v_mov_b32 v161, v81
    v_mov_b32 v162, v84
    v_mov_b32 v163, v85
    v_mov_b32 v164, v88
    v_mov_b32 v165, v89
    v_mov_b32 v166, v92
    v_mov_b32 v167, v93
    v_mov_b32 v168, v96
    v_mov_b32 v169, v97
    v_mov_b32 v170, v100
    v_mov_b32 v171, v101
    v_mov_b32 v172, v104
    v_mov_b32 v173, v105
    v_mov_b32 v174, v108
    v_mov_b32 v175, v109
    v_mov_b32 v176, v112
    v_mov_b32 v177, v113
    v_mov_b32 v178, v116
    v_mov_b32 v179, v117
    v_mov_b32 v180, v120
    v_mov_b32 v181, v121
    v_mov_b32 v182, v124
    v_mov_b32 v183, v125
    v_mov_b32 v184, v128
    v_mov_b32 v185, v129
    v_mov_b32 v186, v132
    v_mov_b32 v187, v133
    v_mov_b32 v188, v136
    v_mov_b32 v189, v137
    v_mov_b32 v190, v140
    v_mov_b32 v191, v141
    v_and_b32 v12, 31, v0
    s_lshl_b32 s44, s40, 6
    s_lshl_b32 s45, s51, 5
    s_add_u32 s44, s44, s45
    v_add_u32 v12, s44, v12
    v_lshlrev_b32 v12, 10, v12
    s_lshl_b32 s44, s41, 7
    s_lshl_b32 s45, s50, 6
    s_add_u32 s63, s44, s45
    v_lshrrev_b32 v13, 5, v0
    v_lshl_add_u32 v14, v13, 3, v12
    v_lshlrev_b32 v1, 3, v13
    buffer_load_dwordx2 v[144:145], v14, s[8:11], s63 offen offset:0
    buffer_load_dwordx2 v[152:153], v1, s[36:39], s63 offen offset:0
    buffer_load_dwordx2 v[146:147], v14, s[8:11], s63 offen offset:16
    buffer_load_dwordx2 v[154:155], v1, s[36:39], s63 offen offset:16
    buffer_load_dwordx2 v[148:149], v14, s[8:11], s63 offen offset:32
    buffer_load_dwordx2 v[156:157], v1, s[36:39], s63 offen offset:32
    buffer_load_dwordx2 v[150:151], v14, s[8:11], s63 offen offset:48
    buffer_load_dwordx2 v[158:159], v1, s[36:39], s63 offen offset:48
    v_lshl_add_u32 v12, v13, 4, v12
    s_waitcnt vmcnt(18)
    v_mfma_f32_32x32x16_bf16 v[80:95], v[160:163], v[48:51], 0
    v_mfma_f32_32x32x16_bf16 v[96:111], v[160:163], v[52:55], 0
    s_lshl_b32 s44, s85, 11
    s_add_u32 s44, s44, s60
    s_add_u32 s85, s85, 1
    s_cmp_eq_u32 s85, 8
    s_cselect_b32 s85, 0, s85
    buffer_load_dwordx4 v[48:51], v2, s[28:31], s44 offen sc1
    buffer_load_dwordx4 v[52:55], v15, s[28:31], s44 offen sc1
    s_nop 3
    v_add_f32 v88, 0x358637bd, v88
    v_rcp_f32 v88, v88
    s_nop 0
    v_mul_f32 v80, v80, v88
    v_mul_f32 v81, v81, v88
    v_mul_f32 v82, v82, v88
    v_mul_f32 v83, v83, v88
    v_mul_f32 v84, v84, v88
    v_mul_f32 v85, v85, v88
    v_mul_f32 v86, v86, v88
    v_mul_f32 v87, v87, v88
    v_cvt_pk_bf16_f32 v128, v80, v81
    v_cvt_pk_bf16_f32 v129, v82, v83
    v_cvt_pk_bf16_f32 v130, v84, v85
    v_cvt_pk_bf16_f32 v131, v86, v87
    s_waitcnt vmcnt(18)
    v_mfma_f32_32x32x16_bf16 v[112:127], v[164:167], v[56:59], 0
    v_add_f32 v104, 0x358637bd, v104
    v_rcp_f32 v104, v104
    s_nop 0
    v_mul_f32 v96, v96, v104
    v_mul_f32 v97, v97, v104
    v_mul_f32 v98, v98, v104
    v_mul_f32 v99, v99, v104
    v_mul_f32 v100, v100, v104
    v_mul_f32 v101, v101, v104
    v_mul_f32 v102, v102, v104
    v_mul_f32 v103, v103, v104
    v_cvt_pk_bf16_f32 v132, v96, v97
    v_cvt_pk_bf16_f32 v133, v98, v99
    v_cvt_pk_bf16_f32 v134, v100, v101
    v_cvt_pk_bf16_f32 v135, v102, v103
    v_mfma_f32_32x32x16_bf16 v[80:95], v[164:167], v[60:63], 0
    s_lshl_b32 s44, s85, 11
    s_add_u32 s44, s44, s60
    s_add_u32 s85, s85, 1
    s_cmp_eq_u32 s85, 8
    s_cselect_b32 s85, 0, s85
    buffer_load_dwordx4 v[56:59], v2, s[28:31], s44 offen sc1
    buffer_load_dwordx4 v[60:63], v15, s[28:31], s44 offen sc1
    s_waitcnt lgkmcnt(0)
    v_mfma_f32_32x32x16_bf16 v[192:207], v[64:67], v[128:131], v[192:207]
    ds_read_b64_tr_b16 v[72:73], v10 offset:0
    v_add_f32 v120, 0x358637bd, v120
    v_rcp_f32 v120, v120
    s_nop 0
    v_mul_f32 v112, v112, v120
    v_mul_f32 v113, v113, v120
    v_mul_f32 v114, v114, v120
    v_mfma_f32_32x32x16_bf16 v[224:239], v[68:71], v[128:131], v[224:239]
    ds_read_b64_tr_b16 v[74:75], v10 offset:1024
    v_mul_f32 v115, v115, v120
    v_mul_f32 v116, v116, v120
    v_mul_f32 v117, v117, v120
    v_mul_f32 v118, v118, v120
    v_mul_f32 v119, v119, v120
    v_mfma_f32_32x32x16_bf16 v[208:223], v[64:67], v[132:135], v[208:223]
    ds_read_b64_tr_b16 v[76:77], v11 offset:0
    v_cvt_pk_bf16_f32 v136, v112, v113
    v_cvt_pk_bf16_f32 v137, v114, v115
    v_cvt_pk_bf16_f32 v138, v116, v117
    v_cvt_pk_bf16_f32 v139, v118, v119
    s_waitcnt vmcnt(18)
    v_mfma_f32_32x32x16_bf16 v[96:111], v[168:171], v[16:19], 0
    v_add_f32 v88, 0x358637bd, v88
    v_rcp_f32 v88, v88
    s_nop 0
    v_mul_f32 v80, v80, v88
    v_mul_f32 v81, v81, v88
    v_mul_f32 v82, v82, v88
    v_mfma_f32_32x32x16_bf16 v[240:255], v[68:71], v[132:135], v[240:255]
    ds_read_b64_tr_b16 v[78:79], v11 offset:1024
    v_mul_f32 v83, v83, v88
    v_mul_f32 v84, v84, v88
    v_mul_f32 v85, v85, v88
    v_mul_f32 v86, v86, v88
    v_mul_f32 v87, v87, v88
    v_cvt_pk_bf16_f32 v140, v80, v81
    v_cvt_pk_bf16_f32 v141, v82, v83
    v_cvt_pk_bf16_f32 v142, v84, v85
    v_cvt_pk_bf16_f32 v143, v86, v87
    v_mfma_f32_32x32x16_bf16 v[112:127], v[168:171], v[20:23], 0
    s_waitcnt lgkmcnt(0)
    v_mfma_f32_32x32x16_bf16 v[192:207], v[72:75], v[136:139], v[192:207]
    ds_read_b64_tr_b16 v[64:65], v10 offset:2048
    v_add_f32 v104, 0x358637bd, v104
    v_rcp_f32 v104, v104
    s_nop 0
    v_mul_f32 v96, v96, v104
    v_mul_f32 v97, v97, v104
    v_mul_f32 v98, v98, v104
    v_mfma_f32_32x32x16_bf16 v[224:239], v[76:79], v[136:139], v[224:239]
    ds_read_b64_tr_b16 v[66:67], v10 offset:3072
    v_mul_f32 v99, v99, v104
    v_mul_f32 v100, v100, v104
    v_mul_f32 v101, v101, v104
    v_mul_f32 v102, v102, v104
    v_mul_f32 v103, v103, v104
    v_mfma_f32_32x32x16_bf16 v[208:223], v[72:75], v[140:143], v[208:223]
    ds_read_b64_tr_b16 v[68:69], v11 offset:2048
    v_cvt_pk_bf16_f32 v128, v96, v97
    v_cvt_pk_bf16_f32 v129, v98, v99
    v_cvt_pk_bf16_f32 v130, v100, v101
    v_cvt_pk_bf16_f32 v131, v102, v103
    s_waitcnt vmcnt(16)
    v_mfma_f32_32x32x16_bf16 v[80:95], v[172:175], v[24:27], 0
    v_add_f32 v120, 0x358637bd, v120
    v_rcp_f32 v120, v120
    s_nop 0
    v_mul_f32 v112, v112, v120
    v_mul_f32 v113, v113, v120
    v_mul_f32 v114, v114, v120
    v_mfma_f32_32x32x16_bf16 v[240:255], v[76:79], v[140:143], v[240:255]
    ds_read_b64_tr_b16 v[70:71], v11 offset:3072
    v_mul_f32 v115, v115, v120
    v_mul_f32 v116, v116, v120
    v_mul_f32 v117, v117, v120
    v_mul_f32 v118, v118, v120
    v_mul_f32 v119, v119, v120
    v_cvt_pk_bf16_f32 v132, v112, v113
    v_cvt_pk_bf16_f32 v133, v114, v115
    v_cvt_pk_bf16_f32 v134, v116, v117
    v_cvt_pk_bf16_f32 v135, v118, v119
    v_mfma_f32_32x32x16_bf16 v[96:111], v[172:175], v[28:31], 0
    s_waitcnt lgkmcnt(0)
    v_mfma_f32_32x32x16_bf16 v[192:207], v[64:67], v[128:131], v[192:207]
    ds_read_b64_tr_b16 v[72:73], v10 offset:4096
    v_add_f32 v88, 0x358637bd, v88
    v_rcp_f32 v88, v88
    s_nop 0
    v_mul_f32 v80, v80, v88
    v_mul_f32 v81, v81, v88
    v_mul_f32 v82, v82, v88
    v_mfma_f32_32x32x16_bf16 v[224:239], v[68:71], v[128:131], v[224:239]
    ds_read_b64_tr_b16 v[74:75], v10 offset:5120
    v_mul_f32 v83, v83, v88
    v_mul_f32 v84, v84, v88
    v_mul_f32 v85, v85, v88
    v_mul_f32 v86, v86, v88
    v_mul_f32 v87, v87, v88
    v_mfma_f32_32x32x16_bf16 v[208:223], v[64:67], v[132:135], v[208:223]
    ds_read_b64_tr_b16 v[76:77], v11 offset:4096
    v_cvt_pk_bf16_f32 v136, v80, v81
    v_cvt_pk_bf16_f32 v137, v82, v83
    v_cvt_pk_bf16_f32 v138, v84, v85
    v_cvt_pk_bf16_f32 v139, v86, v87
    s_waitcnt vmcnt(14)
    v_mfma_f32_32x32x16_bf16 v[112:127], v[176:179], v[32:35], 0
    v_add_f32 v104, 0x358637bd, v104
    v_rcp_f32 v104, v104
    s_nop 0
    v_mul_f32 v96, v96, v104
    v_mul_f32 v97, v97, v104
    v_mul_f32 v98, v98, v104
    v_mfma_f32_32x32x16_bf16 v[240:255], v[68:71], v[132:135], v[240:255]
    ds_read_b64_tr_b16 v[78:79], v11 offset:5120
    v_mul_f32 v99, v99, v104
    v_mul_f32 v100, v100, v104
    v_mul_f32 v101, v101, v104
    v_mul_f32 v102, v102, v104
    v_mul_f32 v103, v103, v104
    v_cvt_pk_bf16_f32 v140, v96, v97
    v_cvt_pk_bf16_f32 v141, v98, v99
    v_cvt_pk_bf16_f32 v142, v100, v101
    v_cvt_pk_bf16_f32 v143, v102, v103
    v_mfma_f32_32x32x16_bf16 v[80:95], v[176:179], v[36:39], 0
    s_waitcnt lgkmcnt(0)
    v_mfma_f32_32x32x16_bf16 v[192:207], v[72:75], v[136:139], v[192:207]
    ds_read_b64_tr_b16 v[64:65], v10 offset:6144
    v_add_f32 v120, 0x358637bd, v120
    v_rcp_f32 v120, v120
    s_nop 0
    v_mul_f32 v112, v112, v120
    v_mul_f32 v113, v113, v120
    v_mul_f32 v114, v114, v120
    v_mfma_f32_32x32x16_bf16 v[224:239], v[76:79], v[136:139], v[224:239]
    ds_read_b64_tr_b16 v[66:67], v10 offset:7168
    v_mul_f32 v115, v115, v120
    v_mul_f32 v116, v116, v120
    v_mul_f32 v117, v117, v120
    v_mul_f32 v118, v118, v120
    v_mul_f32 v119, v119, v120
    v_mfma_f32_32x32x16_bf16 v[208:223], v[72:75], v[140:143], v[208:223]
    ds_read_b64_tr_b16 v[68:69], v11 offset:6144
    v_cvt_pk_bf16_f32 v128, v112, v113
    v_cvt_pk_bf16_f32 v129, v114, v115
    v_cvt_pk_bf16_f32 v130, v116, v117
    v_cvt_pk_bf16_f32 v131, v118, v119
    s_waitcnt vmcnt(12)
    v_mfma_f32_32x32x16_bf16 v[96:111], v[180:183], v[40:43], 0
    v_add_f32 v88, 0x358637bd, v88
    v_rcp_f32 v88, v88
    s_nop 0
    v_mul_f32 v80, v80, v88
    v_mul_f32 v81, v81, v88
    v_mul_f32 v82, v82, v88
    v_mfma_f32_32x32x16_bf16 v[240:255], v[76:79], v[140:143], v[240:255]
    ds_read_b64_tr_b16 v[70:71], v11 offset:7168
    v_mul_f32 v83, v83, v88
    v_mul_f32 v84, v84, v88
    v_mul_f32 v85, v85, v88
    v_mul_f32 v86, v86, v88
    v_mul_f32 v87, v87, v88
    v_cvt_pk_bf16_f32 v132, v80, v81
    v_cvt_pk_bf16_f32 v133, v82, v83
    v_cvt_pk_bf16_f32 v134, v84, v85
    v_cvt_pk_bf16_f32 v135, v86, v87
    v_mfma_f32_32x32x16_bf16 v[112:127], v[180:183], v[44:47], 0
    s_waitcnt lgkmcnt(0)
    v_mfma_f32_32x32x16_bf16 v[192:207], v[64:67], v[128:131], v[192:207]
    ds_read_b64_tr_b16 v[72:73], v10 offset:8192
    v_add_f32 v104, 0x358637bd, v104
    v_rcp_f32 v104, v104
    s_nop 0
    v_mul_f32 v96, v96, v104
    v_mul_f32 v97, v97, v104
    v_mul_f32 v98, v98, v104
    v_mfma_f32_32x32x16_bf16 v[224:239], v[68:71], v[128:131], v[224:239]
    ds_read_b64_tr_b16 v[74:75], v10 offset:9216
    v_mul_f32 v99, v99, v104
    v_mul_f32 v100, v100, v104
    v_mul_f32 v101, v101, v104
    v_mul_f32 v102, v102, v104
    v_mul_f32 v103, v103, v104
    v_mfma_f32_32x32x16_bf16 v[208:223], v[64:67], v[132:135], v[208:223]
    ds_read_b64_tr_b16 v[76:77], v11 offset:8192
    v_cvt_pk_bf16_f32 v136, v96, v97
    v_cvt_pk_bf16_f32 v137, v98, v99
    v_cvt_pk_bf16_f32 v138, v100, v101
    v_cvt_pk_bf16_f32 v139, v102, v103
    s_waitcnt vmcnt(2)
    v_mfma_f32_32x32x16_bf16 v[80:95], v[184:187], v[48:51], 0
    v_add_f32 v120, 0x358637bd, v120
    v_rcp_f32 v120, v120
    s_nop 0
    v_mul_f32 v112, v112, v120
    v_mul_f32 v113, v113, v120
    v_mul_f32 v114, v114, v120
    v_mfma_f32_32x32x16_bf16 v[240:255], v[68:71], v[132:135], v[240:255]
    ds_read_b64_tr_b16 v[78:79], v11 offset:9216
    v_mul_f32 v115, v115, v120
    v_mul_f32 v116, v116, v120
    v_mul_f32 v117, v117, v120
    v_mul_f32 v118, v118, v120
    v_mul_f32 v119, v119, v120
    v_cvt_pk_bf16_f32 v140, v112, v113
    v_cvt_pk_bf16_f32 v141, v114, v115
    v_cvt_pk_bf16_f32 v142, v116, v117
    v_cvt_pk_bf16_f32 v143, v118, v119
    v_mfma_f32_32x32x16_bf16 v[96:111], v[184:187], v[52:55], 0
    s_waitcnt lgkmcnt(0)
    v_mfma_f32_32x32x16_bf16 v[192:207], v[72:75], v[136:139], v[192:207]
    ds_read_b64_tr_b16 v[64:65], v4 offset:0
    v_add_f32 v88, 0x358637bd, v88
    v_rcp_f32 v88, v88
    s_nop 0
    v_mul_f32 v80, v80, v88
    v_mul_f32 v81, v81, v88
    v_mul_f32 v82, v82, v88
    v_mfma_f32_32x32x16_bf16 v[224:239], v[76:79], v[136:139], v[224:239]
    ds_read_b64_tr_b16 v[66:67], v4 offset:1024
    v_mul_f32 v83, v83, v88
    v_mul_f32 v84, v84, v88
    v_mul_f32 v85, v85, v88
    v_mul_f32 v86, v86, v88
    v_mul_f32 v87, v87, v88
    v_mfma_f32_32x32x16_bf16 v[208:223], v[72:75], v[140:143], v[208:223]
    ds_read_b64_tr_b16 v[68:69], v5 offset:0
    v_cvt_pk_bf16_f32 v128, v80, v81
    v_cvt_pk_bf16_f32 v129, v82, v83
    v_cvt_pk_bf16_f32 v130, v84, v85
    v_cvt_pk_bf16_f32 v131, v86, v87
    s_waitcnt vmcnt(0)
    v_mfma_f32_32x32x16_bf16 v[112:127], v[188:191], v[56:59], 0
    v_add_f32 v104, 0x358637bd, v104
    v_rcp_f32 v104, v104
    s_nop 0
    v_mul_f32 v96, v96, v104
    v_mul_f32 v97, v97, v104
    v_mul_f32 v98, v98, v104
    v_mfma_f32_32x32x16_bf16 v[240:255], v[76:79], v[140:143], v[240:255]
    ds_read_b64_tr_b16 v[70:71], v5 offset:1024
    v_mul_f32 v99, v99, v104
    v_mul_f32 v100, v100, v104
    v_mul_f32 v101, v101, v104
    v_mul_f32 v102, v102, v104
    v_mul_f32 v103, v103, v104
    v_cvt_pk_bf16_f32 v132, v96, v97
    v_cvt_pk_bf16_f32 v133, v98, v99
    v_cvt_pk_bf16_f32 v134, v100, v101
    v_cvt_pk_bf16_f32 v135, v102, v103
    v_mfma_f32_32x32x16_bf16 v[80:95], v[188:191], v[60:63], 0
    s_waitcnt lgkmcnt(0)
    v_mfma_f32_32x32x16_bf16 v[192:207], v[64:67], v[128:131], v[192:207]
    ds_read_b64_tr_b16 v[72:73], v4 offset:2048
    v_add_f32 v120, 0x358637bd, v120
    v_rcp_f32 v120, v120
    s_nop 0
    v_mul_f32 v112, v112, v120
    v_mul_f32 v113, v113, v120
    v_mul_f32 v114, v114, v120
    v_mfma_f32_32x32x16_bf16 v[224:239], v[68:71], v[128:131], v[224:239]
    ds_read_b64_tr_b16 v[74:75], v4 offset:3072
    v_mul_f32 v115, v115, v120
    v_mul_f32 v116, v116, v120
    v_mul_f32 v117, v117, v120
    v_mul_f32 v118, v118, v120
    v_mul_f32 v119, v119, v120
    v_mfma_f32_32x32x16_bf16 v[208:223], v[64:67], v[132:135], v[208:223]
    ds_read_b64_tr_b16 v[76:77], v5 offset:2048
    v_cvt_pk_bf16_f32 v136, v112, v113
    v_cvt_pk_bf16_f32 v137, v114, v115
    v_cvt_pk_bf16_f32 v138, v116, v117
    v_cvt_pk_bf16_f32 v139, v118, v119
    v_add_f32 v88, 0x358637bd, v88
    v_rcp_f32 v88, v88
    s_nop 0
    v_mul_f32 v80, v80, v88
    v_mul_f32 v81, v81, v88
    v_mul_f32 v82, v82, v88
    v_mfma_f32_32x32x16_bf16 v[240:255], v[68:71], v[132:135], v[240:255]
    ds_read_b64_tr_b16 v[78:79], v5 offset:3072
    v_mul_f32 v83, v83, v88
    v_mul_f32 v84, v84, v88
    v_mul_f32 v85, v85, v88
    v_mul_f32 v86, v86, v88
    v_mul_f32 v87, v87, v88
    v_cvt_pk_bf16_f32 v140, v80, v81
    v_cvt_pk_bf16_f32 v141, v82, v83
    v_cvt_pk_bf16_f32 v142, v84, v85
    v_cvt_pk_bf16_f32 v143, v86, v87
    s_waitcnt lgkmcnt(0)
    v_mfma_f32_32x32x16_bf16 v[192:207], v[72:75], v[136:139], v[192:207]
    v_mfma_f32_32x32x16_bf16 v[224:239], v[76:79], v[136:139], v[224:239]
    v_mfma_f32_32x32x16_bf16 v[208:223], v[72:75], v[140:143], v[208:223]
    v_mfma_f32_32x32x16_bf16 v[240:255], v[76:79], v[140:143], v[240:255]
    v_lshlrev_b32 v13, 4, v0
    v_add_u32 v14, s55, v13
    v_add_u32 v1, s54, v13
    s_mov_b32 s46, 0xffff0000
    s_nop 5
    ds_write_b128 v14, v[224:227] offset:0
    v_lshlrev_b32 v16, 16, v144
    v_and_b32 v17, s46, v144
    v_lshlrev_b32 v18, 16, v152
    v_and_b32 v19, s46, v152
    v_add_f32 v16, v16, v18
    v_add_f32 v17, v17, v19
    ds_write_b128 v14, v[228:231] offset:1024
    v_add_f32 v192, v192, v16
    v_add_f32 v193, v193, v17
    v_lshlrev_b32 v20, 16, v145
    v_and_b32 v21, s46, v145
    v_lshlrev_b32 v22, 16, v153
    v_and_b32 v23, s46, v153
    ds_write_b128 v14, v[232:235] offset:2048
    v_add_f32 v20, v20, v22
    v_add_f32 v21, v21, v23
    v_add_f32 v194, v194, v20
    v_add_f32 v195, v195, v21
    v_lshlrev_b32 v16, 16, v146
    v_and_b32 v17, s46, v146
    ds_write_b128 v14, v[236:239] offset:3072
    v_lshlrev_b32 v18, 16, v154
    v_and_b32 v19, s46, v154
    v_add_f32 v16, v16, v18
    v_add_f32 v17, v17, v19
    v_add_f32 v196, v196, v16
    v_add_f32 v197, v197, v17
    ds_write_b128 v14, v[208:211] offset:4096
    v_lshlrev_b32 v20, 16, v147
    v_and_b32 v21, s46, v147
    v_lshlrev_b32 v22, 16, v155
    v_and_b32 v23, s46, v155
    v_add_f32 v20, v20, v22
    v_add_f32 v21, v21, v23
    ds_write_b128 v14, v[212:215] offset:5120
    v_add_f32 v198, v198, v20
    v_add_f32 v199, v199, v21
    v_lshlrev_b32 v16, 16, v148
    v_and_b32 v17, s46, v148
    v_lshlrev_b32 v18, 16, v156
    v_and_b32 v19, s46, v156
    ds_write_b128 v14, v[216:219] offset:6144
    v_add_f32 v16, v16, v18
    v_add_f32 v17, v17, v19
    v_add_f32 v200, v200, v16
    v_add_f32 v201, v201, v17
    v_lshlrev_b32 v20, 16, v149
    v_and_b32 v21, s46, v149
    ds_write_b128 v14, v[220:223] offset:7168
    v_lshlrev_b32 v22, 16, v157
    v_and_b32 v23, s46, v157
    v_add_f32 v20, v20, v22
    v_add_f32 v21, v21, v23
    v_add_f32 v202, v202, v20
    v_add_f32 v203, v203, v21
    ds_write_b128 v1, v[240:243] offset:0
    v_lshlrev_b32 v16, 16, v150
    v_and_b32 v17, s46, v150
    v_lshlrev_b32 v18, 16, v158
    v_and_b32 v19, s46, v158
    v_add_f32 v16, v16, v18
    v_add_f32 v17, v17, v19
    ds_write_b128 v1, v[244:247] offset:1024
    v_add_f32 v204, v204, v16
    v_add_f32 v205, v205, v17
    v_lshlrev_b32 v20, 16, v151
    v_and_b32 v21, s46, v151
    v_lshlrev_b32 v22, 16, v159
    v_and_b32 v23, s46, v159
    ds_write_b128 v1, v[248:251] offset:2048
    v_add_f32 v20, v20, v22
    v_add_f32 v21, v21, v23
    v_add_f32 v206, v206, v20
    v_add_f32 v207, v207, v21
    ds_write_b128 v1, v[252:255] offset:3072
    s_xor_b32 s44, s49, 1
    s_mul_i32 s44, s44, 10240
    s_add_u32 s44, s44, 40960
    v_add_u32 v5, s44, v13
    s_xor_b32 s44, s49, 2
    s_mul_i32 s44, s44, 10240
    s_add_u32 s44, s44, 45056
    v_add_u32 v6, s44, v13
    s_xor_b32 s44, s49, 3
    s_mul_i32 s44, s44, 10240
    s_add_u32 s44, s44, 0
    v_add_u32 v7, s44, v13
    s_waitcnt lgkmcnt(0)
    s_barrier
    ds_read_b128 v[64:67], v5 offset:0
    ds_read_b128 v[68:71], v5 offset:1024
    ds_read_b128 v[72:75], v5 offset:2048
    ds_read_b128 v[76:79], v5 offset:3072
    ds_read_b128 v[80:83], v6 offset:0
    ds_read_b128 v[84:87], v6 offset:1024
    ds_read_b128 v[88:91], v6 offset:2048
    ds_read_b128 v[92:95], v6 offset:3072
    ds_read_b128 v[96:99], v7 offset:0
    ds_read_b128 v[100:103], v7 offset:1024
    ds_read_b128 v[104:107], v7 offset:2048
    ds_read_b128 v[108:111], v7 offset:3072
    s_waitcnt lgkmcnt(8)
    v_add_f32 v192, v192, v64
    v_add_f32 v193, v193, v65
    v_add_f32 v194, v194, v66
    v_add_f32 v195, v195, v67
    v_add_f32 v196, v196, v68
    v_add_f32 v197, v197, v69
    v_add_f32 v198, v198, v70
    v_add_f32 v199, v199, v71
    v_add_f32 v200, v200, v72
    v_add_f32 v201, v201, v73
    v_add_f32 v202, v202, v74
    v_add_f32 v203, v203, v75
    v_add_f32 v204, v204, v76
    v_add_f32 v205, v205, v77
    v_add_f32 v206, v206, v78
    v_add_f32 v207, v207, v79
    s_waitcnt lgkmcnt(4)
    v_add_f32 v192, v192, v80
    v_add_f32 v193, v193, v81
    v_add_f32 v194, v194, v82
    v_add_f32 v195, v195, v83
    v_add_f32 v196, v196, v84
    v_add_f32 v197, v197, v85
    v_add_f32 v198, v198, v86
    v_add_f32 v199, v199, v87
    v_add_f32 v200, v200, v88
    v_add_f32 v201, v201, v89
    v_add_f32 v202, v202, v90
    v_add_f32 v203, v203, v91
    v_add_f32 v204, v204, v92
    v_add_f32 v205, v205, v93
    v_add_f32 v206, v206, v94
    v_add_f32 v207, v207, v95
    s_waitcnt lgkmcnt(0)
    v_add_f32 v192, v192, v96
    v_add_f32 v193, v193, v97
    v_cvt_pk_bf16_f32 v16, v192, v193
    v_add_f32 v194, v194, v98
    v_add_f32 v195, v195, v99
    v_cvt_pk_bf16_f32 v17, v194, v195
    v_add_f32 v196, v196, v100
    v_add_f32 v197, v197, v101
    v_cvt_pk_bf16_f32 v18, v196, v197
    v_add_f32 v198, v198, v102
    v_add_f32 v199, v199, v103
    v_cvt_pk_bf16_f32 v19, v198, v199
    v_add_f32 v200, v200, v104
    v_add_f32 v201, v201, v105
    v_cvt_pk_bf16_f32 v20, v200, v201
    v_add_f32 v202, v202, v106
    v_add_f32 v203, v203, v107
    v_cvt_pk_bf16_f32 v21, v202, v203
    v_add_f32 v204, v204, v108
    v_add_f32 v205, v205, v109
    v_cvt_pk_bf16_f32 v22, v204, v205
    v_add_f32 v206, v206, v110
    v_add_f32 v207, v207, v111
    v_cvt_pk_bf16_f32 v23, v206, v207
    v_permlane32_swap_b32 v16, v18
    v_permlane32_swap_b32 v17, v19
    v_permlane32_swap_b32 v20, v22
    v_permlane32_swap_b32 v21, v23
    buffer_store_dwordx4 v[16:19], v12, s[32:35], s63 offen
    buffer_store_dwordx4 v[20:23], v12, s[32:35], s63 offen offset:32
L_END:
    s_endpgm
.section .rodata,"a"
.p2align 6
.amdhsa_kernel parallel_sum__linear_attn_block__dense_activation_gelu__prompt_kernel
  .amdhsa_next_free_vgpr 256
  .amdhsa_next_free_sgpr 102
  .amdhsa_accum_offset 256
  .amdhsa_group_segment_fixed_size 0
  .amdhsa_kernarg_size 88
  .amdhsa_user_sgpr_count 2
  .amdhsa_user_sgpr_kernarg_segment_ptr 1
  .amdhsa_system_sgpr_workgroup_id_x 1
.end_amdhsa_kernel
```
